```python
import torch

def _softmax(x, axis=-1):
    return torch.softmax(x, dim=axis)

def _gelu(x):
    return torch.nn.functional.gelu(x, approximate='tanh')

def _silu(x):
    return torch.nn.functional.silu(x)

def _sigmoid(x):
    return torch.sigmoid(x)

def _layernorm(x, axis=-1, eps=1e-05):
    m = x.mean(dim=axis, keepdim=True)
    v = x.var(dim=axis, keepdim=True, unbiased=False)
    return (x - m) / torch.sqrt(v + eps)

def _scatter_add(tgt, idx, src, axis=0):
    return tgt.clone().index_add_(axis, idx, src)

def _segment_sum(src, seg, n):
    out = torch.zeros((n,) + src.shape[1:], dtype=src.dtype)
    return out.index_add_(0, seg, src)

def _pad(x, pw):
    flat = tuple((v for pair in reversed(pw) for v in pair))
    return torch.nn.functional.pad(x, flat)
kernel_name = 'adaLN_cond__gqa_block_cached__glu_gated_geglu__prompt'

def setup_inputs():

    _w = lambda a: (lambda t: t.to(torch.bfloat16) if t.is_floating_point() else t)(torch.as_tensor(a))

    def _A_setup():
        B, Sq, D = (1, 2048, 512)
        Hq, Hkv, Sk, Dh = (32, 8, 2048, 128)
        assert Hq % Hkv == 0, (Hq, Hkv)
        return {'x': _w((lambda *s: torch.randn(*s, dtype=torch.bfloat16) * 0.05)(B, Sq, D)), 'k_cache': _w((lambda *s: torch.randn(*s, dtype=torch.bfloat16) * 0.8)(B, Hkv, Sk, Dh)), 'v_cache': _w((lambda *s: torch.randn(*s, dtype=torch.bfloat16) * 3.2)(B, Hkv, Sk, Dh)), 'wq': _w((lambda *s: torch.randn(*s, dtype=torch.bfloat16) * 0.8)(D, Hq * Dh) * D ** (-0.5)), 'wo': _w((lambda *s: torch.randn(*s, dtype=torch.bfloat16) * 3.2)(Hq * Dh, D) * (Hq * Dh) ** (-0.5))}
    _A_in = _A_setup()

    def _B_setup():
        B, S, Dm, Df = (1, 2048, 512, 1792)
        return {'x': _w((lambda *s: torch.randn(*s, dtype=torch.bfloat16) * 0.05)(B, S, Dm)), 'w_gate': _w((lambda *s: torch.randn(*s, dtype=torch.bfloat16) * 3.2)(Dm, Df) * Dm ** (-0.5)), 'w_up': _w((lambda *s: torch.randn(*s, dtype=torch.bfloat16) * 3.2)(Dm, Df) * Dm ** (-0.5)), 'w_down': _w((lambda *s: torch.randn(*s, dtype=torch.bfloat16) * 3.2)(Df, Dm) * Df ** (-0.5))}
    _B_in = _B_setup()
    return {'A_x': _A_in['x'], 'A_k_cache': _A_in['k_cache'], 'A_v_cache': _A_in['v_cache'], 'A_wq': _A_in['wq'], 'A_wo': _A_in['wo'], 'B_x': _B_in['x'], 'B_w_gate': _B_in['w_gate'], 'B_w_up': _B_in['w_up'], 'B_w_down': _B_in['w_down'], 'c': _w((lambda *s: torch.randn(*s, dtype=torch.bfloat16) * 0.4)(1, 512) * 8.0), 'w_mod': _w((lambda *s: torch.randn(*s, dtype=torch.bfloat16) * 0.4)(512, 6 * 512) * 512 ** (-0.5) * 8.0)}

def reference(A_x, A_k_cache, A_v_cache, A_wq, A_wo, B_x, B_w_gate, B_w_up, B_w_down, c, w_mod):

    def _A_ref(x, k_cache, v_cache, wq, wo):
        B, Sq, D = x.shape
        Hq, Dh = (32, 128)
        Hkv = k_cache.shape[1]
        rep = Hq // Hkv
        q = (lambda x, *d: x.permute(*d))((x @ wq).reshape(B, Sq, Hq, Dh), 0, 2, 1, 3)
        k = (lambda x, n, axis: torch.repeat_interleave(x, n, dim=axis))(k_cache, rep, axis=1)
        v = (lambda x, n, axis: torch.repeat_interleave(x, n, dim=axis))(v_cache, rep, axis=1)
        scores = torch.einsum('bhqd,bhkd->bhqk', q, k) * Dh ** (-0.5)
        p = _softmax(scores, axis=-1)
        o = torch.einsum('bhqk,bhkd->bhqd', p, v)
        return (lambda x, *d: x.permute(*d))(o, 0, 2, 1, 3).reshape(B, Sq, Hq * Dh) @ wo

    def _B_ref(x, w_gate, w_up, w_down):
        g = torch.einsum('bsd,df->bsf', x, w_gate)
        u = torch.einsum('bsd,df->bsf', x, w_up)
        h = _gelu(g) * u
        return torch.einsum('bsf,fd->bsd', h, w_down)
    x = A_x
    mod = (_silu(c) @ w_mod).reshape(c.shape[0], 6, 1, -1)
    sa, ca, ga, sb, cb, gb = (mod[:, 0].clone(), mod[:, 1].clone(), mod[:, 2].clone(), mod[:, 3].clone(), mod[:, 4].clone(), mod[:, 5].clone())
    h = _layernorm(x, axis=-1) * (1 + ca) + sa
    x = x + ga * _A_ref(h, A_k_cache, A_v_cache, A_wq, A_wo)
    h = _layernorm(x, axis=-1) * (1 + cb) + sb
    x = x + gb * _B_ref(h, B_w_gate, B_w_up, B_w_down)
    return x
```

```asm
; @launch kernel=mod_kernel grid=(24,1,1) block=(1024,1,1) lds=8192
; @launch kernel=ln1_kernel grid=(512,1,1) block=(256,1,1) lds=0
; @launch kernel=qproj_kernel grid=(256,1,1) block=(512,1,1) lds=147456
; @launch kernel=attn_kernel grid=(256,1,1) block=(512,1,1) lds=65536
; @launch kernel=wo_kernel grid=(256,1,1) block=(512,1,1) lds=147456
; @launch kernel=ln2_kernel grid=(512,1,1) block=(256,1,1) lds=0
; @launch kernel=gateup_kernel grid=(224,1,1) block=(512,1,1) lds=147456
; @launch kernel=down_kernel grid=(224,1,1) block=(512,1,1) lds=147456
; @launch kernel=final_kernel grid=(512,1,1) block=(256,1,1) lds=0
.amdgcn_target "amdgcn-amd-amdhsa--gfx950"
.text
.globl mod_kernel
.p2align 8
.type mod_kernel,@function
mod_kernel:
    s_cmp_ge_u32 s2, 24
    s_cbranch_scc1 mod_done
    s_load_dwordx2 s[4:5], s[0:1], 72
    s_load_dwordx2 s[6:7], s[0:1], 80
    s_load_dwordx2 s[8:9], s[0:1], 104
    v_lshrrev_b32 v1, 6, v0
    v_and_b32 v2, 63, v0
    s_nop 0
    v_readfirstlane_b32 s10, v1
    s_waitcnt lgkmcnt(0)
    s_lshl_b32 s11, s10, 6
    s_add_u32 s4, s4, s11
    s_addc_u32 s5, s5, 0
    s_load_dwordx16 s[16:31], s[4:5], 0
    s_mov_b32 s12, s6
    s_mov_b32 s13, s7
    s_mov_b32 s14, 3145728
    s_mov_b32 s15, 0x00020000
    s_mov_b32 s36, s8
    s_mov_b32 s37, s9
    s_mov_b32 s38, 12288
    s_mov_b32 s39, 0x00020000
    s_mul_i32 s11, s10, 196608
    s_lshl_b32 s33, s2, 8
    s_add_u32 s11, s11, s33
    v_lshlrev_b32 v3, 2, v2
    v_add_u32 v3, s11, v3
    s_mov_b32 s33, 0
    buffer_load_dword v32, v3, s[12:15], s33 offen
    s_mov_b32 s33, 6144
    buffer_load_dword v33, v3, s[12:15], s33 offen
    s_mov_b32 s33, 12288
    buffer_load_dword v34, v3, s[12:15], s33 offen
    s_mov_b32 s33, 18432
    buffer_load_dword v35, v3, s[12:15], s33 offen
    s_mov_b32 s33, 24576
    buffer_load_dword v36, v3, s[12:15], s33 offen
    s_mov_b32 s33, 30720
    buffer_load_dword v37, v3, s[12:15], s33 offen
    s_mov_b32 s33, 36864
    buffer_load_dword v38, v3, s[12:15], s33 offen
    s_mov_b32 s33, 43008
    buffer_load_dword v39, v3, s[12:15], s33 offen
    s_mov_b32 s33, 49152
    buffer_load_dword v40, v3, s[12:15], s33 offen
    s_mov_b32 s33, 55296
    buffer_load_dword v41, v3, s[12:15], s33 offen
    s_mov_b32 s33, 61440
    buffer_load_dword v42, v3, s[12:15], s33 offen
    s_mov_b32 s33, 67584
    buffer_load_dword v43, v3, s[12:15], s33 offen
    s_mov_b32 s33, 73728
    buffer_load_dword v44, v3, s[12:15], s33 offen
    s_mov_b32 s33, 79872
    buffer_load_dword v45, v3, s[12:15], s33 offen
    s_mov_b32 s33, 86016
    buffer_load_dword v46, v3, s[12:15], s33 offen
    s_mov_b32 s33, 92160
    buffer_load_dword v47, v3, s[12:15], s33 offen
    s_mov_b32 s33, 98304
    buffer_load_dword v48, v3, s[12:15], s33 offen
    s_mov_b32 s33, 104448
    buffer_load_dword v49, v3, s[12:15], s33 offen
    s_mov_b32 s33, 110592
    buffer_load_dword v50, v3, s[12:15], s33 offen
    s_mov_b32 s33, 116736
    buffer_load_dword v51, v3, s[12:15], s33 offen
    s_mov_b32 s33, 122880
    buffer_load_dword v52, v3, s[12:15], s33 offen
    s_mov_b32 s33, 129024
    buffer_load_dword v53, v3, s[12:15], s33 offen
    s_mov_b32 s33, 135168
    buffer_load_dword v54, v3, s[12:15], s33 offen
    s_mov_b32 s33, 141312
    buffer_load_dword v55, v3, s[12:15], s33 offen
    s_mov_b32 s33, 147456
    buffer_load_dword v56, v3, s[12:15], s33 offen
    s_mov_b32 s33, 153600
    buffer_load_dword v57, v3, s[12:15], s33 offen
    s_mov_b32 s33, 159744
    buffer_load_dword v58, v3, s[12:15], s33 offen
    s_mov_b32 s33, 165888
    buffer_load_dword v59, v3, s[12:15], s33 offen
    s_mov_b32 s33, 172032
    buffer_load_dword v60, v3, s[12:15], s33 offen
    s_mov_b32 s33, 178176
    buffer_load_dword v61, v3, s[12:15], s33 offen
    s_mov_b32 s33, 184320
    buffer_load_dword v62, v3, s[12:15], s33 offen
    s_mov_b32 s33, 190464
    buffer_load_dword v63, v3, s[12:15], s33 offen
    s_waitcnt lgkmcnt(0)
    v_mov_b32 v4, 0
    v_mov_b32 v5, 0
    v_lshlrev_b32 v6, 16, s16
    v_mul_f32 v7, 0xbfb8aa3b, v6
    v_exp_f32 v7, v7
    s_nop 0
    v_add_f32 v7, 1.0, v7
    v_rcp_f32 v7, v7
    s_nop 0
    v_mul_f32 v6, v6, v7
    v_cvt_pk_bf16_f32 v6, v6, v6
    v_lshlrev_b32 v6, 16, v6
    s_waitcnt vmcnt(31)
    v_lshlrev_b32 v8, 16, v32
    v_and_b32 v9, 0xffff0000, v32
    v_fmac_f32 v4, v6, v8
    v_fmac_f32 v5, v6, v9
    s_and_b32 s33, s16, 0xffff0000
    v_mov_b32 v6, s33
    v_mul_f32 v7, 0xbfb8aa3b, v6
    v_exp_f32 v7, v7
    s_nop 0
    v_add_f32 v7, 1.0, v7
    v_rcp_f32 v7, v7
    s_nop 0
    v_mul_f32 v6, v6, v7
    v_cvt_pk_bf16_f32 v6, v6, v6
    v_lshlrev_b32 v6, 16, v6
    s_waitcnt vmcnt(30)
    v_lshlrev_b32 v8, 16, v33
    v_and_b32 v9, 0xffff0000, v33
    v_fmac_f32 v4, v6, v8
    v_fmac_f32 v5, v6, v9
    v_lshlrev_b32 v6, 16, s17
    v_mul_f32 v7, 0xbfb8aa3b, v6
    v_exp_f32 v7, v7
    s_nop 0
    v_add_f32 v7, 1.0, v7
    v_rcp_f32 v7, v7
    s_nop 0
    v_mul_f32 v6, v6, v7
    v_cvt_pk_bf16_f32 v6, v6, v6
    v_lshlrev_b32 v6, 16, v6
    s_waitcnt vmcnt(29)
    v_lshlrev_b32 v8, 16, v34
    v_and_b32 v9, 0xffff0000, v34
    v_fmac_f32 v4, v6, v8
    v_fmac_f32 v5, v6, v9
    s_and_b32 s33, s17, 0xffff0000
    v_mov_b32 v6, s33
    v_mul_f32 v7, 0xbfb8aa3b, v6
    v_exp_f32 v7, v7
    s_nop 0
    v_add_f32 v7, 1.0, v7
    v_rcp_f32 v7, v7
    s_nop 0
    v_mul_f32 v6, v6, v7
    v_cvt_pk_bf16_f32 v6, v6, v6
    v_lshlrev_b32 v6, 16, v6
    s_waitcnt vmcnt(28)
    v_lshlrev_b32 v8, 16, v35
    v_and_b32 v9, 0xffff0000, v35
    v_fmac_f32 v4, v6, v8
    v_fmac_f32 v5, v6, v9
    v_lshlrev_b32 v6, 16, s18
    v_mul_f32 v7, 0xbfb8aa3b, v6
    v_exp_f32 v7, v7
    s_nop 0
    v_add_f32 v7, 1.0, v7
    v_rcp_f32 v7, v7
    s_nop 0
    v_mul_f32 v6, v6, v7
    v_cvt_pk_bf16_f32 v6, v6, v6
    v_lshlrev_b32 v6, 16, v6
    s_waitcnt vmcnt(27)
    v_lshlrev_b32 v8, 16, v36
    v_and_b32 v9, 0xffff0000, v36
    v_fmac_f32 v4, v6, v8
    v_fmac_f32 v5, v6, v9
    s_and_b32 s33, s18, 0xffff0000
    v_mov_b32 v6, s33
    v_mul_f32 v7, 0xbfb8aa3b, v6
    v_exp_f32 v7, v7
    s_nop 0
    v_add_f32 v7, 1.0, v7
    v_rcp_f32 v7, v7
    s_nop 0
    v_mul_f32 v6, v6, v7
    v_cvt_pk_bf16_f32 v6, v6, v6
    v_lshlrev_b32 v6, 16, v6
    s_waitcnt vmcnt(26)
    v_lshlrev_b32 v8, 16, v37
    v_and_b32 v9, 0xffff0000, v37
    v_fmac_f32 v4, v6, v8
    v_fmac_f32 v5, v6, v9
    v_lshlrev_b32 v6, 16, s19
    v_mul_f32 v7, 0xbfb8aa3b, v6
    v_exp_f32 v7, v7
    s_nop 0
    v_add_f32 v7, 1.0, v7
    v_rcp_f32 v7, v7
    s_nop 0
    v_mul_f32 v6, v6, v7
    v_cvt_pk_bf16_f32 v6, v6, v6
    v_lshlrev_b32 v6, 16, v6
    s_waitcnt vmcnt(25)
    v_lshlrev_b32 v8, 16, v38
    v_and_b32 v9, 0xffff0000, v38
    v_fmac_f32 v4, v6, v8
    v_fmac_f32 v5, v6, v9
    s_and_b32 s33, s19, 0xffff0000
    v_mov_b32 v6, s33
    v_mul_f32 v7, 0xbfb8aa3b, v6
    v_exp_f32 v7, v7
    s_nop 0
    v_add_f32 v7, 1.0, v7
    v_rcp_f32 v7, v7
    s_nop 0
    v_mul_f32 v6, v6, v7
    v_cvt_pk_bf16_f32 v6, v6, v6
    v_lshlrev_b32 v6, 16, v6
    s_waitcnt vmcnt(24)
    v_lshlrev_b32 v8, 16, v39
    v_and_b32 v9, 0xffff0000, v39
    v_fmac_f32 v4, v6, v8
    v_fmac_f32 v5, v6, v9
    v_lshlrev_b32 v6, 16, s20
    v_mul_f32 v7, 0xbfb8aa3b, v6
    v_exp_f32 v7, v7
    s_nop 0
    v_add_f32 v7, 1.0, v7
    v_rcp_f32 v7, v7
    s_nop 0
    v_mul_f32 v6, v6, v7
    v_cvt_pk_bf16_f32 v6, v6, v6
    v_lshlrev_b32 v6, 16, v6
    s_waitcnt vmcnt(23)
    v_lshlrev_b32 v8, 16, v40
    v_and_b32 v9, 0xffff0000, v40
    v_fmac_f32 v4, v6, v8
    v_fmac_f32 v5, v6, v9
    s_and_b32 s33, s20, 0xffff0000
    v_mov_b32 v6, s33
    v_mul_f32 v7, 0xbfb8aa3b, v6
    v_exp_f32 v7, v7
    s_nop 0
    v_add_f32 v7, 1.0, v7
    v_rcp_f32 v7, v7
    s_nop 0
    v_mul_f32 v6, v6, v7
    v_cvt_pk_bf16_f32 v6, v6, v6
    v_lshlrev_b32 v6, 16, v6
    s_waitcnt vmcnt(22)
    v_lshlrev_b32 v8, 16, v41
    v_and_b32 v9, 0xffff0000, v41
    v_fmac_f32 v4, v6, v8
    v_fmac_f32 v5, v6, v9
    v_lshlrev_b32 v6, 16, s21
    v_mul_f32 v7, 0xbfb8aa3b, v6
    v_exp_f32 v7, v7
    s_nop 0
    v_add_f32 v7, 1.0, v7
    v_rcp_f32 v7, v7
    s_nop 0
    v_mul_f32 v6, v6, v7
    v_cvt_pk_bf16_f32 v6, v6, v6
    v_lshlrev_b32 v6, 16, v6
    s_waitcnt vmcnt(21)
    v_lshlrev_b32 v8, 16, v42
    v_and_b32 v9, 0xffff0000, v42
    v_fmac_f32 v4, v6, v8
    v_fmac_f32 v5, v6, v9
    s_and_b32 s33, s21, 0xffff0000
    v_mov_b32 v6, s33
    v_mul_f32 v7, 0xbfb8aa3b, v6
    v_exp_f32 v7, v7
    s_nop 0
    v_add_f32 v7, 1.0, v7
    v_rcp_f32 v7, v7
    s_nop 0
    v_mul_f32 v6, v6, v7
    v_cvt_pk_bf16_f32 v6, v6, v6
    v_lshlrev_b32 v6, 16, v6
    s_waitcnt vmcnt(20)
    v_lshlrev_b32 v8, 16, v43
    v_and_b32 v9, 0xffff0000, v43
    v_fmac_f32 v4, v6, v8
    v_fmac_f32 v5, v6, v9
    v_lshlrev_b32 v6, 16, s22
    v_mul_f32 v7, 0xbfb8aa3b, v6
    v_exp_f32 v7, v7
    s_nop 0
    v_add_f32 v7, 1.0, v7
    v_rcp_f32 v7, v7
    s_nop 0
    v_mul_f32 v6, v6, v7
    v_cvt_pk_bf16_f32 v6, v6, v6
    v_lshlrev_b32 v6, 16, v6
    s_waitcnt vmcnt(19)
    v_lshlrev_b32 v8, 16, v44
    v_and_b32 v9, 0xffff0000, v44
    v_fmac_f32 v4, v6, v8
    v_fmac_f32 v5, v6, v9
    s_and_b32 s33, s22, 0xffff0000
    v_mov_b32 v6, s33
    v_mul_f32 v7, 0xbfb8aa3b, v6
    v_exp_f32 v7, v7
    s_nop 0
    v_add_f32 v7, 1.0, v7
    v_rcp_f32 v7, v7
    s_nop 0
    v_mul_f32 v6, v6, v7
    v_cvt_pk_bf16_f32 v6, v6, v6
    v_lshlrev_b32 v6, 16, v6
    s_waitcnt vmcnt(18)
    v_lshlrev_b32 v8, 16, v45
    v_and_b32 v9, 0xffff0000, v45
    v_fmac_f32 v4, v6, v8
    v_fmac_f32 v5, v6, v9
    v_lshlrev_b32 v6, 16, s23
    v_mul_f32 v7, 0xbfb8aa3b, v6
    v_exp_f32 v7, v7
    s_nop 0
    v_add_f32 v7, 1.0, v7
    v_rcp_f32 v7, v7
    s_nop 0
    v_mul_f32 v6, v6, v7
    v_cvt_pk_bf16_f32 v6, v6, v6
    v_lshlrev_b32 v6, 16, v6
    s_waitcnt vmcnt(17)
    v_lshlrev_b32 v8, 16, v46
    v_and_b32 v9, 0xffff0000, v46
    v_fmac_f32 v4, v6, v8
    v_fmac_f32 v5, v6, v9
    s_and_b32 s33, s23, 0xffff0000
    v_mov_b32 v6, s33
    v_mul_f32 v7, 0xbfb8aa3b, v6
    v_exp_f32 v7, v7
    s_nop 0
    v_add_f32 v7, 1.0, v7
    v_rcp_f32 v7, v7
    s_nop 0
    v_mul_f32 v6, v6, v7
    v_cvt_pk_bf16_f32 v6, v6, v6
    v_lshlrev_b32 v6, 16, v6
    s_waitcnt vmcnt(16)
    v_lshlrev_b32 v8, 16, v47
    v_and_b32 v9, 0xffff0000, v47
    v_fmac_f32 v4, v6, v8
    v_fmac_f32 v5, v6, v9
    v_lshlrev_b32 v6, 16, s24
    v_mul_f32 v7, 0xbfb8aa3b, v6
    v_exp_f32 v7, v7
    s_nop 0
    v_add_f32 v7, 1.0, v7
    v_rcp_f32 v7, v7
    s_nop 0
    v_mul_f32 v6, v6, v7
    v_cvt_pk_bf16_f32 v6, v6, v6
    v_lshlrev_b32 v6, 16, v6
    s_waitcnt vmcnt(15)
    v_lshlrev_b32 v8, 16, v48
    v_and_b32 v9, 0xffff0000, v48
    v_fmac_f32 v4, v6, v8
    v_fmac_f32 v5, v6, v9
    s_and_b32 s33, s24, 0xffff0000
    v_mov_b32 v6, s33
    v_mul_f32 v7, 0xbfb8aa3b, v6
    v_exp_f32 v7, v7
    s_nop 0
    v_add_f32 v7, 1.0, v7
    v_rcp_f32 v7, v7
    s_nop 0
    v_mul_f32 v6, v6, v7
    v_cvt_pk_bf16_f32 v6, v6, v6
    v_lshlrev_b32 v6, 16, v6
    s_waitcnt vmcnt(14)
    v_lshlrev_b32 v8, 16, v49
    v_and_b32 v9, 0xffff0000, v49
    v_fmac_f32 v4, v6, v8
    v_fmac_f32 v5, v6, v9
    v_lshlrev_b32 v6, 16, s25
    v_mul_f32 v7, 0xbfb8aa3b, v6
    v_exp_f32 v7, v7
    s_nop 0
    v_add_f32 v7, 1.0, v7
    v_rcp_f32 v7, v7
    s_nop 0
    v_mul_f32 v6, v6, v7
    v_cvt_pk_bf16_f32 v6, v6, v6
    v_lshlrev_b32 v6, 16, v6
    s_waitcnt vmcnt(13)
    v_lshlrev_b32 v8, 16, v50
    v_and_b32 v9, 0xffff0000, v50
    v_fmac_f32 v4, v6, v8
    v_fmac_f32 v5, v6, v9
    s_and_b32 s33, s25, 0xffff0000
    v_mov_b32 v6, s33
    v_mul_f32 v7, 0xbfb8aa3b, v6
    v_exp_f32 v7, v7
    s_nop 0
    v_add_f32 v7, 1.0, v7
    v_rcp_f32 v7, v7
    s_nop 0
    v_mul_f32 v6, v6, v7
    v_cvt_pk_bf16_f32 v6, v6, v6
    v_lshlrev_b32 v6, 16, v6
    s_waitcnt vmcnt(12)
    v_lshlrev_b32 v8, 16, v51
    v_and_b32 v9, 0xffff0000, v51
    v_fmac_f32 v4, v6, v8
    v_fmac_f32 v5, v6, v9
    v_lshlrev_b32 v6, 16, s26
    v_mul_f32 v7, 0xbfb8aa3b, v6
    v_exp_f32 v7, v7
    s_nop 0
    v_add_f32 v7, 1.0, v7
    v_rcp_f32 v7, v7
    s_nop 0
    v_mul_f32 v6, v6, v7
    v_cvt_pk_bf16_f32 v6, v6, v6
    v_lshlrev_b32 v6, 16, v6
    s_waitcnt vmcnt(11)
    v_lshlrev_b32 v8, 16, v52
    v_and_b32 v9, 0xffff0000, v52
    v_fmac_f32 v4, v6, v8
    v_fmac_f32 v5, v6, v9
    s_and_b32 s33, s26, 0xffff0000
    v_mov_b32 v6, s33
    v_mul_f32 v7, 0xbfb8aa3b, v6
    v_exp_f32 v7, v7
    s_nop 0
    v_add_f32 v7, 1.0, v7
    v_rcp_f32 v7, v7
    s_nop 0
    v_mul_f32 v6, v6, v7
    v_cvt_pk_bf16_f32 v6, v6, v6
    v_lshlrev_b32 v6, 16, v6
    s_waitcnt vmcnt(10)
    v_lshlrev_b32 v8, 16, v53
    v_and_b32 v9, 0xffff0000, v53
    v_fmac_f32 v4, v6, v8
    v_fmac_f32 v5, v6, v9
    v_lshlrev_b32 v6, 16, s27
    v_mul_f32 v7, 0xbfb8aa3b, v6
    v_exp_f32 v7, v7
    s_nop 0
    v_add_f32 v7, 1.0, v7
    v_rcp_f32 v7, v7
    s_nop 0
    v_mul_f32 v6, v6, v7
    v_cvt_pk_bf16_f32 v6, v6, v6
    v_lshlrev_b32 v6, 16, v6
    s_waitcnt vmcnt(9)
    v_lshlrev_b32 v8, 16, v54
    v_and_b32 v9, 0xffff0000, v54
    v_fmac_f32 v4, v6, v8
    v_fmac_f32 v5, v6, v9
    s_and_b32 s33, s27, 0xffff0000
    v_mov_b32 v6, s33
    v_mul_f32 v7, 0xbfb8aa3b, v6
    v_exp_f32 v7, v7
    s_nop 0
    v_add_f32 v7, 1.0, v7
    v_rcp_f32 v7, v7
    s_nop 0
    v_mul_f32 v6, v6, v7
    v_cvt_pk_bf16_f32 v6, v6, v6
    v_lshlrev_b32 v6, 16, v6
    s_waitcnt vmcnt(8)
    v_lshlrev_b32 v8, 16, v55
    v_and_b32 v9, 0xffff0000, v55
    v_fmac_f32 v4, v6, v8
    v_fmac_f32 v5, v6, v9
    v_lshlrev_b32 v6, 16, s28
    v_mul_f32 v7, 0xbfb8aa3b, v6
    v_exp_f32 v7, v7
    s_nop 0
    v_add_f32 v7, 1.0, v7
    v_rcp_f32 v7, v7
    s_nop 0
    v_mul_f32 v6, v6, v7
    v_cvt_pk_bf16_f32 v6, v6, v6
    v_lshlrev_b32 v6, 16, v6
    s_waitcnt vmcnt(7)
    v_lshlrev_b32 v8, 16, v56
    v_and_b32 v9, 0xffff0000, v56
    v_fmac_f32 v4, v6, v8
    v_fmac_f32 v5, v6, v9
    s_and_b32 s33, s28, 0xffff0000
    v_mov_b32 v6, s33
    v_mul_f32 v7, 0xbfb8aa3b, v6
    v_exp_f32 v7, v7
    s_nop 0
    v_add_f32 v7, 1.0, v7
    v_rcp_f32 v7, v7
    s_nop 0
    v_mul_f32 v6, v6, v7
    v_cvt_pk_bf16_f32 v6, v6, v6
    v_lshlrev_b32 v6, 16, v6
    s_waitcnt vmcnt(6)
    v_lshlrev_b32 v8, 16, v57
    v_and_b32 v9, 0xffff0000, v57
    v_fmac_f32 v4, v6, v8
    v_fmac_f32 v5, v6, v9
    v_lshlrev_b32 v6, 16, s29
    v_mul_f32 v7, 0xbfb8aa3b, v6
    v_exp_f32 v7, v7
    s_nop 0
    v_add_f32 v7, 1.0, v7
    v_rcp_f32 v7, v7
    s_nop 0
    v_mul_f32 v6, v6, v7
    v_cvt_pk_bf16_f32 v6, v6, v6
    v_lshlrev_b32 v6, 16, v6
    s_waitcnt vmcnt(5)
    v_lshlrev_b32 v8, 16, v58
    v_and_b32 v9, 0xffff0000, v58
    v_fmac_f32 v4, v6, v8
    v_fmac_f32 v5, v6, v9
    s_and_b32 s33, s29, 0xffff0000
    v_mov_b32 v6, s33
    v_mul_f32 v7, 0xbfb8aa3b, v6
    v_exp_f32 v7, v7
    s_nop 0
    v_add_f32 v7, 1.0, v7
    v_rcp_f32 v7, v7
    s_nop 0
    v_mul_f32 v6, v6, v7
    v_cvt_pk_bf16_f32 v6, v6, v6
    v_lshlrev_b32 v6, 16, v6
    s_waitcnt vmcnt(4)
    v_lshlrev_b32 v8, 16, v59
    v_and_b32 v9, 0xffff0000, v59
    v_fmac_f32 v4, v6, v8
    v_fmac_f32 v5, v6, v9
    v_lshlrev_b32 v6, 16, s30
    v_mul_f32 v7, 0xbfb8aa3b, v6
    v_exp_f32 v7, v7
    s_nop 0
    v_add_f32 v7, 1.0, v7
    v_rcp_f32 v7, v7
    s_nop 0
    v_mul_f32 v6, v6, v7
    v_cvt_pk_bf16_f32 v6, v6, v6
    v_lshlrev_b32 v6, 16, v6
    s_waitcnt vmcnt(3)
    v_lshlrev_b32 v8, 16, v60
    v_and_b32 v9, 0xffff0000, v60
    v_fmac_f32 v4, v6, v8
    v_fmac_f32 v5, v6, v9
    s_and_b32 s33, s30, 0xffff0000
    v_mov_b32 v6, s33
    v_mul_f32 v7, 0xbfb8aa3b, v6
    v_exp_f32 v7, v7
    s_nop 0
    v_add_f32 v7, 1.0, v7
    v_rcp_f32 v7, v7
    s_nop 0
    v_mul_f32 v6, v6, v7
    v_cvt_pk_bf16_f32 v6, v6, v6
    v_lshlrev_b32 v6, 16, v6
    s_waitcnt vmcnt(2)
    v_lshlrev_b32 v8, 16, v61
    v_and_b32 v9, 0xffff0000, v61
    v_fmac_f32 v4, v6, v8
    v_fmac_f32 v5, v6, v9
    v_lshlrev_b32 v6, 16, s31
    v_mul_f32 v7, 0xbfb8aa3b, v6
    v_exp_f32 v7, v7
    s_nop 0
    v_add_f32 v7, 1.0, v7
    v_rcp_f32 v7, v7
    s_nop 0
    v_mul_f32 v6, v6, v7
    v_cvt_pk_bf16_f32 v6, v6, v6
    v_lshlrev_b32 v6, 16, v6
    s_waitcnt vmcnt(1)
    v_lshlrev_b32 v8, 16, v62
    v_and_b32 v9, 0xffff0000, v62
    v_fmac_f32 v4, v6, v8
    v_fmac_f32 v5, v6, v9
    s_and_b32 s33, s31, 0xffff0000
    v_mov_b32 v6, s33
    v_mul_f32 v7, 0xbfb8aa3b, v6
    v_exp_f32 v7, v7
    s_nop 0
    v_add_f32 v7, 1.0, v7
    v_rcp_f32 v7, v7
    s_nop 0
    v_mul_f32 v6, v6, v7
    v_cvt_pk_bf16_f32 v6, v6, v6
    v_lshlrev_b32 v6, 16, v6
    s_waitcnt vmcnt(0)
    v_lshlrev_b32 v8, 16, v63
    v_and_b32 v9, 0xffff0000, v63
    v_fmac_f32 v4, v6, v8
    v_fmac_f32 v5, v6, v9
    v_lshlrev_b32 v10, 9, v1
    v_lshlrev_b32 v11, 3, v2
    v_add_u32 v10, v10, v11
    ds_write_b64 v10, v[4:5]
    s_waitcnt lgkmcnt(0)
    s_barrier
    v_cmp_gt_u32 vcc, 128, v0
    s_and_saveexec_b64 s[34:35], vcc
    s_cbranch_execz mod_done
    v_lshlrev_b32 v10, 2, v0
    ds_read_b32 v32, v10 offset:0
    ds_read_b32 v33, v10 offset:512
    ds_read_b32 v34, v10 offset:1024
    ds_read_b32 v35, v10 offset:1536
    ds_read_b32 v36, v10 offset:2048
    ds_read_b32 v37, v10 offset:2560
    ds_read_b32 v38, v10 offset:3072
    ds_read_b32 v39, v10 offset:3584
    ds_read_b32 v40, v10 offset:4096
    ds_read_b32 v41, v10 offset:4608
    ds_read_b32 v42, v10 offset:5120
    ds_read_b32 v43, v10 offset:5632
    ds_read_b32 v44, v10 offset:6144
    ds_read_b32 v45, v10 offset:6656
    ds_read_b32 v46, v10 offset:7168
    ds_read_b32 v47, v10 offset:7680
    s_waitcnt lgkmcnt(0)
    v_mov_b32 v4, v32
    v_add_f32 v4, v4, v33
    v_add_f32 v4, v4, v34
    v_add_f32 v4, v4, v35
    v_add_f32 v4, v4, v36
    v_add_f32 v4, v4, v37
    v_add_f32 v4, v4, v38
    v_add_f32 v4, v4, v39
    v_add_f32 v4, v4, v40
    v_add_f32 v4, v4, v41
    v_add_f32 v4, v4, v42
    v_add_f32 v4, v4, v43
    v_add_f32 v4, v4, v44
    v_add_f32 v4, v4, v45
    v_add_f32 v4, v4, v46
    v_add_f32 v4, v4, v47
    v_cvt_pk_bf16_f32 v4, v4, v4
    v_lshlrev_b32 v4, 16, v4
    s_lshl_b32 s33, s2, 9
    v_add_u32 v10, s33, v10
    buffer_store_dword v4, v10, s[36:39], 0 offen
mod_done:
    s_endpgm
.globl ln1_kernel
.p2align 8
.type ln1_kernel,@function
ln1_kernel:
    s_cmp_ge_u32 s2, 512
    s_cbranch_scc1 ln1_kernel_done
    s_load_dwordx2 s[4:5], s[0:1], 0
    s_load_dwordx2 s[8:9], s[0:1], 104
    v_lshrrev_b32 v1, 6, v0
    v_and_b32 v2, 63, v0
    s_lshl_b32 s3, s2, 2
    v_add_u32 v1, s3, v1
    s_waitcnt lgkmcnt(0)
    s_mov_b32 s12, s4
    s_mov_b32 s13, s5
    s_mov_b32 s14, 2097152
    s_mov_b32 s15, 0x00020000
    s_mov_b32 s16, s8
    s_mov_b32 s17, s9
    s_mov_b32 s18, 12288
    s_mov_b32 s19, 0x00020000
    s_add_u32 s20, s8, 70254592
    s_addc_u32 s21, s9, 0
    s_mov_b32 s22, 2097152
    s_mov_b32 s23, 0x00020000
    v_xor_b32 v10, 1, v2
    v_lshlrev_b32 v10, 2, v10
    v_xor_b32 v11, 2, v2
    v_lshlrev_b32 v11, 2, v11
    v_xor_b32 v12, 4, v2
    v_lshlrev_b32 v12, 2, v12
    v_xor_b32 v13, 8, v2
    v_lshlrev_b32 v13, 2, v13
    v_xor_b32 v14, 16, v2
    v_lshlrev_b32 v14, 2, v14
    v_xor_b32 v15, 32, v2
    v_lshlrev_b32 v15, 2, v15
    v_lshlrev_b32 v3, 10, v1
    v_lshlrev_b32 v4, 4, v2
    v_add_u32 v3, v3, v4
    v_lshlrev_b32 v5, 1, v3
    v_lshlrev_b32 v6, 5, v2
    buffer_load_dwordx4 v[16:19], v3, s[12:15], 0 offen
    s_mov_b32 s33, 2048
    buffer_load_dwordx4 v[32:35], v6, s[16:19], s33 offen
    buffer_load_dwordx4 v[36:39], v6, s[16:19], s33 offen offset:16
    s_mov_b32 s33, 0
    buffer_load_dwordx4 v[40:43], v6, s[16:19], s33 offen
    buffer_load_dwordx4 v[44:47], v6, s[16:19], s33 offen offset:16
    s_waitcnt vmcnt(0)
    v_lshlrev_b32 v20, 16, v16
    v_and_b32 v21, 0xffff0000, v16
    v_lshlrev_b32 v22, 16, v17
    v_and_b32 v23, 0xffff0000, v17
    v_lshlrev_b32 v24, 16, v18
    v_and_b32 v25, 0xffff0000, v18
    v_lshlrev_b32 v26, 16, v19
    v_and_b32 v27, 0xffff0000, v19
    v_add_f32 v7, v20, v21
    v_add_f32 v7, v7, v22
    v_add_f32 v7, v7, v23
    v_add_f32 v7, v7, v24
    v_add_f32 v7, v7, v25
    v_add_f32 v7, v7, v26
    v_add_f32 v7, v7, v27
    ds_bpermute_b32 v8, v10, v7
    s_waitcnt lgkmcnt(0)
    v_add_f32 v7, v7, v8
    ds_bpermute_b32 v8, v11, v7
    s_waitcnt lgkmcnt(0)
    v_add_f32 v7, v7, v8
    ds_bpermute_b32 v8, v12, v7
    s_waitcnt lgkmcnt(0)
    v_add_f32 v7, v7, v8
    ds_bpermute_b32 v8, v13, v7
    s_waitcnt lgkmcnt(0)
    v_add_f32 v7, v7, v8
    ds_bpermute_b32 v8, v14, v7
    s_waitcnt lgkmcnt(0)
    v_add_f32 v7, v7, v8
    ds_bpermute_b32 v8, v15, v7
    s_waitcnt lgkmcnt(0)
    v_add_f32 v7, v7, v8
    v_mul_f32 v7, 0x3b000000, v7
    v_mov_b32 v9, 0
    v_sub_f32 v8, v20, v7
    v_fmac_f32 v9, v8, v8
    v_sub_f32 v8, v21, v7
    v_fmac_f32 v9, v8, v8
    v_sub_f32 v8, v22, v7
    v_fmac_f32 v9, v8, v8
    v_sub_f32 v8, v23, v7
    v_fmac_f32 v9, v8, v8
    v_sub_f32 v8, v24, v7
    v_fmac_f32 v9, v8, v8
    v_sub_f32 v8, v25, v7
    v_fmac_f32 v9, v8, v8
    v_sub_f32 v8, v26, v7
    v_fmac_f32 v9, v8, v8
    v_sub_f32 v8, v27, v7
    v_fmac_f32 v9, v8, v8
    ds_bpermute_b32 v8, v10, v9
    s_waitcnt lgkmcnt(0)
    v_add_f32 v9, v9, v8
    ds_bpermute_b32 v8, v11, v9
    s_waitcnt lgkmcnt(0)
    v_add_f32 v9, v9, v8
    ds_bpermute_b32 v8, v12, v9
    s_waitcnt lgkmcnt(0)
    v_add_f32 v9, v9, v8
    ds_bpermute_b32 v8, v13, v9
    s_waitcnt lgkmcnt(0)
    v_add_f32 v9, v9, v8
    ds_bpermute_b32 v8, v14, v9
    s_waitcnt lgkmcnt(0)
    v_add_f32 v9, v9, v8
    ds_bpermute_b32 v8, v15, v9
    s_waitcnt lgkmcnt(0)
    v_add_f32 v9, v9, v8
    v_mul_f32 v9, 0x3b000000, v9
    v_cvt_pk_bf16_f32 v7, v7, v7
    v_lshlrev_b32 v7, 16, v7
    v_cvt_pk_bf16_f32 v9, v9, v9
    v_lshlrev_b32 v9, 16, v9
    v_add_f32 v9, 0x3727c5ac, v9
    v_cvt_pk_bf16_f32 v9, v9, v9
    v_lshlrev_b32 v9, 16, v9
    v_sqrt_f32 v9, v9
    s_nop 0
    v_cvt_pk_bf16_f32 v9, v9, v9
    v_lshlrev_b32 v9, 16, v9
    v_rcp_f32 v8, v9
    s_nop 0
    v_sub_f32 v20, v20, v7
    v_cvt_pk_bf16_f32 v20, v20, v20
    v_lshlrev_b32 v20, 16, v20
    v_mul_f32 v28, v20, v8
    v_fma_f32 v29, -v28, v9, v20
    v_fma_f32 v20, v29, v8, v28
    v_cvt_pk_bf16_f32 v20, v20, v20
    v_lshlrev_b32 v20, 16, v20
    v_add_f32 v32, 1.0, v32
    v_cvt_pk_bf16_f32 v32, v32, v32
    v_lshlrev_b32 v32, 16, v32
    v_mul_f32 v20, v20, v32
    v_cvt_pk_bf16_f32 v20, v20, v20
    v_lshlrev_b32 v20, 16, v20
    v_add_f32 v20, v20, v40
    v_sub_f32 v21, v21, v7
    v_cvt_pk_bf16_f32 v21, v21, v21
    v_lshlrev_b32 v21, 16, v21
    v_mul_f32 v28, v21, v8
    v_fma_f32 v29, -v28, v9, v21
    v_fma_f32 v21, v29, v8, v28
    v_cvt_pk_bf16_f32 v21, v21, v21
    v_lshlrev_b32 v21, 16, v21
    v_add_f32 v33, 1.0, v33
    v_cvt_pk_bf16_f32 v33, v33, v33
    v_lshlrev_b32 v33, 16, v33
    v_mul_f32 v21, v21, v33
    v_cvt_pk_bf16_f32 v21, v21, v21
    v_lshlrev_b32 v21, 16, v21
    v_add_f32 v21, v21, v41
    v_sub_f32 v22, v22, v7
    v_cvt_pk_bf16_f32 v22, v22, v22
    v_lshlrev_b32 v22, 16, v22
    v_mul_f32 v28, v22, v8
    v_fma_f32 v29, -v28, v9, v22
    v_fma_f32 v22, v29, v8, v28
    v_cvt_pk_bf16_f32 v22, v22, v22
    v_lshlrev_b32 v22, 16, v22
    v_add_f32 v34, 1.0, v34
    v_cvt_pk_bf16_f32 v34, v34, v34
    v_lshlrev_b32 v34, 16, v34
    v_mul_f32 v22, v22, v34
    v_cvt_pk_bf16_f32 v22, v22, v22
    v_lshlrev_b32 v22, 16, v22
    v_add_f32 v22, v22, v42
    v_sub_f32 v23, v23, v7
    v_cvt_pk_bf16_f32 v23, v23, v23
    v_lshlrev_b32 v23, 16, v23
    v_mul_f32 v28, v23, v8
    v_fma_f32 v29, -v28, v9, v23
    v_fma_f32 v23, v29, v8, v28
    v_cvt_pk_bf16_f32 v23, v23, v23
    v_lshlrev_b32 v23, 16, v23
    v_add_f32 v35, 1.0, v35
    v_cvt_pk_bf16_f32 v35, v35, v35
    v_lshlrev_b32 v35, 16, v35
    v_mul_f32 v23, v23, v35
    v_cvt_pk_bf16_f32 v23, v23, v23
    v_lshlrev_b32 v23, 16, v23
    v_add_f32 v23, v23, v43
    v_sub_f32 v24, v24, v7
    v_cvt_pk_bf16_f32 v24, v24, v24
    v_lshlrev_b32 v24, 16, v24
    v_mul_f32 v28, v24, v8
    v_fma_f32 v29, -v28, v9, v24
    v_fma_f32 v24, v29, v8, v28
    v_cvt_pk_bf16_f32 v24, v24, v24
    v_lshlrev_b32 v24, 16, v24
    v_add_f32 v36, 1.0, v36
    v_cvt_pk_bf16_f32 v36, v36, v36
    v_lshlrev_b32 v36, 16, v36
    v_mul_f32 v24, v24, v36
    v_cvt_pk_bf16_f32 v24, v24, v24
    v_lshlrev_b32 v24, 16, v24
    v_add_f32 v24, v24, v44
    v_sub_f32 v25, v25, v7
    v_cvt_pk_bf16_f32 v25, v25, v25
    v_lshlrev_b32 v25, 16, v25
    v_mul_f32 v28, v25, v8
    v_fma_f32 v29, -v28, v9, v25
    v_fma_f32 v25, v29, v8, v28
    v_cvt_pk_bf16_f32 v25, v25, v25
    v_lshlrev_b32 v25, 16, v25
    v_add_f32 v37, 1.0, v37
    v_cvt_pk_bf16_f32 v37, v37, v37
    v_lshlrev_b32 v37, 16, v37
    v_mul_f32 v25, v25, v37
    v_cvt_pk_bf16_f32 v25, v25, v25
    v_lshlrev_b32 v25, 16, v25
    v_add_f32 v25, v25, v45
    v_sub_f32 v26, v26, v7
    v_cvt_pk_bf16_f32 v26, v26, v26
    v_lshlrev_b32 v26, 16, v26
    v_mul_f32 v28, v26, v8
    v_fma_f32 v29, -v28, v9, v26
    v_fma_f32 v26, v29, v8, v28
    v_cvt_pk_bf16_f32 v26, v26, v26
    v_lshlrev_b32 v26, 16, v26
    v_add_f32 v38, 1.0, v38
    v_cvt_pk_bf16_f32 v38, v38, v38
    v_lshlrev_b32 v38, 16, v38
    v_mul_f32 v26, v26, v38
    v_cvt_pk_bf16_f32 v26, v26, v26
    v_lshlrev_b32 v26, 16, v26
    v_add_f32 v26, v26, v46
    v_sub_f32 v27, v27, v7
    v_cvt_pk_bf16_f32 v27, v27, v27
    v_lshlrev_b32 v27, 16, v27
    v_mul_f32 v28, v27, v8
    v_fma_f32 v29, -v28, v9, v27
    v_fma_f32 v27, v29, v8, v28
    v_cvt_pk_bf16_f32 v27, v27, v27
    v_lshlrev_b32 v27, 16, v27
    v_add_f32 v39, 1.0, v39
    v_cvt_pk_bf16_f32 v39, v39, v39
    v_lshlrev_b32 v39, 16, v39
    v_mul_f32 v27, v27, v39
    v_cvt_pk_bf16_f32 v27, v27, v27
    v_lshlrev_b32 v27, 16, v27
    v_add_f32 v27, v27, v47
    v_cvt_pk_bf16_f32 v16, v20, v21
    v_cvt_pk_bf16_f32 v17, v22, v23
    v_cvt_pk_bf16_f32 v18, v24, v25
    v_cvt_pk_bf16_f32 v19, v26, v27
    buffer_store_dwordx4 v[16:19], v3, s[20:23], 0 offen
ln1_kernel_done:
    s_endpgm
.globl qproj_kernel
.p2align 8
.type qproj_kernel,@function
qproj_kernel:
    s_cmp_ge_u32 s2, 256
    s_cbranch_scc1 qproj_kernel_done
    s_load_dwordx2 s[4:5], s[0:1], 24
    s_load_dwordx2 s[6:7], s[0:1], 24
    s_load_dwordx2 s[8:9], s[0:1], 104
    s_and_b32 s40, s2, 15
    s_lshr_b32 s41, s2, 4
    s_mov_b32 s42, s41
    s_mov_b32 s43, 0
    v_and_b32 v1, 63, v0
    v_lshrrev_b32 v2, 6, v0
    s_nop 0
    v_readfirstlane_b32 s50, v2
    s_waitcnt lgkmcnt(0)
    s_add_u32 s12, s8, 70254592
    s_addc_u32 s13, s9, 0
    s_mov_b32 s14, 2097152
    s_mov_b32 s15, 0x00020000
    s_mov_b32 s16, s4
    s_mov_b32 s17, s5
    s_mov_b32 s18, 4194304
    s_mov_b32 s19, 0x00020000
    s_mov_b32 s20, s6
    s_mov_b32 s21, s7
    s_mov_b32 s22, 4194304
    s_mov_b32 s23, 0x00020000
    v_lshrrev_b32 v3, 3, v1
    v_lshlrev_b32 v4, 3, v2
    v_add_u32 v3, v3, v4
    v_lshrrev_b32 v5, 1, v3
    v_and_b32 v5, 7, v5
    v_and_b32 v4, 7, v1
    v_xor_b32 v4, v4, v5
    s_lshl_b32 s44, s40, 7
    v_add_u32 v5, s44, v3
    s_mov_b32 s45, 1024
    v_mul_lo_u32 v5, v5, s45
    v_lshlrev_b32 v6, 4, v4
    v_add_u32 v5, v5, v6
    s_mul_i32 s46, s43, 1024
    v_add_u32 v10, s46, v5
    v_add_u32 v11, 65536, v10
    s_lshl_b32 s51, s50, 10
    v_lshrrev_b32 v3, 5, v1
    v_lshlrev_b32 v4, 1, v2
    v_add_u32 v3, v3, v4
    v_and_b32 v5, 3, v3
    v_lshlrev_b32 v5, 2, v5
    v_and_b32 v4, 31, v1
    v_xor_b32 v4, v4, v5
    s_mul_i32 s46, s43, 512
    v_add_u32 v5, s46, v3
    s_mov_b32 s45, 8192
    v_mul_lo_u32 v5, v5, s45
    v_lshlrev_b32 v6, 4, v4
    v_add_u32 v5, v5, v6
    s_lshl_b32 s46, s42, 9
    v_add_u32 v13, s46, v5
    v_add_u32 v14, 131072, v13
    v_add_u32 v15, 262144, v13
    v_add_u32 v16, 393216, v13
    v_and_b32 v3, 31, v1
    v_and_b32 v4, 1, v2
    v_lshlrev_b32 v4, 6, v4
    v_add_u32 v4, v4, v3
    v_lshrrev_b32 v5, 1, v4
    v_and_b32 v5, 7, v5
    v_lshrrev_b32 v6, 5, v1
    v_lshlrev_b32 v7, 7, v4
    v_add_u32 v8, 0, v6
    v_xor_b32 v8, v8, v5
    v_lshlrev_b32 v8, 4, v8
    v_add_u32 v20, v7, v8
    v_add_u32 v8, 2, v6
    v_xor_b32 v8, v8, v5
    v_lshlrev_b32 v8, 4, v8
    v_add_u32 v21, v7, v8
    v_add_u32 v8, 4, v6
    v_xor_b32 v8, v8, v5
    v_lshlrev_b32 v8, 4, v8
    v_add_u32 v22, v7, v8
    v_add_u32 v8, 6, v6
    v_xor_b32 v8, v8, v5
    v_lshlrev_b32 v8, 4, v8
    v_add_u32 v23, v7, v8
    v_lshrrev_b32 v3, 4, v1
    v_and_b32 v4, 15, v1
    v_lshrrev_b32 v5, 1, v2
    v_lshlrev_b32 v5, 3, v5
    v_and_b32 v6, 1, v3
    v_lshlrev_b32 v6, 1, v6
    v_add_u32 v5, v5, v6
    v_and_b32 v6, 3, v4
    v_lshrrev_b32 v6, 1, v6
    v_add_u32 v5, v5, v6
    v_lshrrev_b32 v6, 2, v4
    v_lshrrev_b32 v7, 1, v3
    v_lshlrev_b32 v7, 3, v7
    v_add_u32 v7, v7, v6
    v_lshlrev_b32 v7, 9, v7
    v_and_b32 v8, 1, v4
    v_lshlrev_b32 v8, 3, v8
    v_add_u32 v7, v7, v8
    v_lshlrev_b32 v6, 2, v6
    v_add_u32 v8, 0, v5
    v_xor_b32 v8, v8, v6
    v_lshlrev_b32 v8, 4, v8
    v_add_u32 v8, v8, v7
    v_add_u32 v24, 16384, v8
    v_add_u32 v8, 4, v5
    v_xor_b32 v8, v8, v6
    v_lshlrev_b32 v8, 4, v8
    v_add_u32 v8, v8, v7
    v_add_u32 v25, 16384, v8
    v_add_u32 v28, 49152, v20
    v_add_u32 v29, 49152, v21
    v_add_u32 v30, 49152, v22
    v_add_u32 v31, 49152, v23
    v_add_u32 v32, 49152, v24
    v_add_u32 v33, 49152, v25
    v_add_u32 v36, 98304, v20
    v_add_u32 v37, 98304, v21
    v_add_u32 v38, 98304, v22
    v_add_u32 v39, 98304, v23
    v_add_u32 v40, 98304, v24
    v_add_u32 v41, 98304, v25
    v_mov_b32 v64, 0
    v_mov_b32 v65, 0
    v_mov_b32 v66, 0
    v_mov_b32 v67, 0
    v_mov_b32 v68, 0
    v_mov_b32 v69, 0
    v_mov_b32 v70, 0
    v_mov_b32 v71, 0
    v_mov_b32 v72, 0
    v_mov_b32 v73, 0
    v_mov_b32 v74, 0
    v_mov_b32 v75, 0
    v_mov_b32 v76, 0
    v_mov_b32 v77, 0
    v_mov_b32 v78, 0
    v_mov_b32 v79, 0
    v_mov_b32 v80, 0
    v_mov_b32 v81, 0
    v_mov_b32 v82, 0
    v_mov_b32 v83, 0
    v_mov_b32 v84, 0
    v_mov_b32 v85, 0
    v_mov_b32 v86, 0
    v_mov_b32 v87, 0
    v_mov_b32 v88, 0
    v_mov_b32 v89, 0
    v_mov_b32 v90, 0
    v_mov_b32 v91, 0
    v_mov_b32 v92, 0
    v_mov_b32 v93, 0
    v_mov_b32 v94, 0
    v_mov_b32 v95, 0
    v_mov_b32 v96, 0
    v_mov_b32 v97, 0
    v_mov_b32 v98, 0
    v_mov_b32 v99, 0
    v_mov_b32 v100, 0
    v_mov_b32 v101, 0
    v_mov_b32 v102, 0
    v_mov_b32 v103, 0
    v_mov_b32 v104, 0
    v_mov_b32 v105, 0
    v_mov_b32 v106, 0
    v_mov_b32 v107, 0
    v_mov_b32 v108, 0
    v_mov_b32 v109, 0
    v_mov_b32 v110, 0
    v_mov_b32 v111, 0
    v_mov_b32 v112, 0
    v_mov_b32 v113, 0
    v_mov_b32 v114, 0
    v_mov_b32 v115, 0
    v_mov_b32 v116, 0
    v_mov_b32 v117, 0
    v_mov_b32 v118, 0
    v_mov_b32 v119, 0
    v_mov_b32 v120, 0
    v_mov_b32 v121, 0
    v_mov_b32 v122, 0
    v_mov_b32 v123, 0
    v_mov_b32 v124, 0
    v_mov_b32 v125, 0
    v_mov_b32 v126, 0
    v_mov_b32 v127, 0
    s_mov_b32 s47, 0
    s_mov_b32 s48, 0
    s_add_u32 m0, s51, 0
    s_nop 0
    buffer_load_dwordx4 v10, s[12:15], s47 offen lds
    s_add_u32 m0, s51, 8192
    s_nop 0
    buffer_load_dwordx4 v11, s[12:15], s47 offen lds
    s_add_u32 m0, s51, 16384
    s_nop 0
    buffer_load_dwordx4 v13, s[16:19], s48 offen lds
    s_add_u32 m0, s51, 24576
    s_nop 0
    buffer_load_dwordx4 v14, s[16:19], s48 offen lds
    s_add_u32 m0, s51, 32768
    s_nop 0
    buffer_load_dwordx4 v15, s[16:19], s48 offen lds
    s_add_u32 m0, s51, 40960
    s_nop 0
    buffer_load_dwordx4 v16, s[16:19], s48 offen lds
    s_mov_b32 s47, 128
    s_mov_b32 s48, 524288
    s_add_u32 m0, s51, 49152
    s_nop 0
    buffer_load_dwordx4 v10, s[12:15], s47 offen lds
    s_add_u32 m0, s51, 57344
    s_nop 0
    buffer_load_dwordx4 v11, s[12:15], s47 offen lds
    s_add_u32 m0, s51, 65536
    s_nop 0
    buffer_load_dwordx4 v13, s[16:19], s48 offen lds
    s_add_u32 m0, s51, 73728
    s_nop 0
    buffer_load_dwordx4 v14, s[16:19], s48 offen lds
    s_add_u32 m0, s51, 81920
    s_nop 0
    buffer_load_dwordx4 v15, s[16:19], s48 offen lds
    s_add_u32 m0, s51, 90112
    s_nop 0
    buffer_load_dwordx4 v16, s[16:19], s48 offen lds
    s_waitcnt vmcnt(6)
    s_barrier
    s_mov_b32 s47, 256
    s_mov_b32 s48, 1048576
    s_add_u32 m0, s51, 98304
    s_nop 0
    buffer_load_dwordx4 v10, s[12:15], s47 offen lds
    s_add_u32 m0, s51, 106496
    s_nop 0
    buffer_load_dwordx4 v11, s[12:15], s47 offen lds
    s_add_u32 m0, s51, 114688
    s_nop 0
    buffer_load_dwordx4 v13, s[16:19], s48 offen lds
    s_add_u32 m0, s51, 122880
    s_nop 0
    buffer_load_dwordx4 v14, s[16:19], s48 offen lds
    s_add_u32 m0, s51, 131072
    s_nop 0
    buffer_load_dwordx4 v15, s[16:19], s48 offen lds
    s_add_u32 m0, s51, 139264
    s_nop 0
    buffer_load_dwordx4 v16, s[16:19], s48 offen lds
    ds_read_b128 v[128:131], v20 offset:0
    ds_read_b128 v[132:135], v20 offset:4096
    ds_read_b64_tr_b16 v[136:137], v24 offset:0
    ds_read_b64_tr_b16 v[138:139], v24 offset:2048
    ds_read_b64_tr_b16 v[140:141], v25 offset:0
    ds_read_b64_tr_b16 v[142:143], v25 offset:2048
    ds_read_b128 v[144:147], v21 offset:0
    ds_read_b128 v[148:151], v21 offset:4096
    ds_read_b64_tr_b16 v[152:153], v24 offset:8192
    ds_read_b64_tr_b16 v[154:155], v24 offset:10240
    ds_read_b64_tr_b16 v[156:157], v25 offset:8192
    ds_read_b64_tr_b16 v[158:159], v25 offset:10240
    ds_read_b128 v[160:163], v22 offset:0
    ds_read_b128 v[164:167], v22 offset:4096
    ds_read_b64_tr_b16 v[168:169], v24 offset:16384
    ds_read_b64_tr_b16 v[170:171], v24 offset:18432
    ds_read_b64_tr_b16 v[172:173], v25 offset:16384
    ds_read_b64_tr_b16 v[174:175], v25 offset:18432
    s_waitcnt lgkmcnt(12)
    v_mfma_f32_32x32x16_bf16 v[64:79], v[136:139], v[128:131], v[64:79]
    v_mfma_f32_32x32x16_bf16 v[80:95], v[136:139], v[132:135], v[80:95]
    v_mfma_f32_32x32x16_bf16 v[96:111], v[140:143], v[128:131], v[96:111]
    v_mfma_f32_32x32x16_bf16 v[112:127], v[140:143], v[132:135], v[112:127]
    ds_read_b128 v[128:131], v23 offset:0
    ds_read_b128 v[132:135], v23 offset:4096
    ds_read_b64_tr_b16 v[136:137], v24 offset:24576
    ds_read_b64_tr_b16 v[138:139], v24 offset:26624
    ds_read_b64_tr_b16 v[140:141], v25 offset:24576
    ds_read_b64_tr_b16 v[142:143], v25 offset:26624
    s_waitcnt lgkmcnt(12)
    v_mfma_f32_32x32x16_bf16 v[64:79], v[152:155], v[144:147], v[64:79]
    v_mfma_f32_32x32x16_bf16 v[80:95], v[152:155], v[148:151], v[80:95]
    v_mfma_f32_32x32x16_bf16 v[96:111], v[156:159], v[144:147], v[96:111]
    v_mfma_f32_32x32x16_bf16 v[112:127], v[156:159], v[148:151], v[112:127]
    s_waitcnt lgkmcnt(6)
    v_mfma_f32_32x32x16_bf16 v[64:79], v[168:171], v[160:163], v[64:79]
    v_mfma_f32_32x32x16_bf16 v[80:95], v[168:171], v[164:167], v[80:95]
    v_mfma_f32_32x32x16_bf16 v[96:111], v[172:175], v[160:163], v[96:111]
    v_mfma_f32_32x32x16_bf16 v[112:127], v[172:175], v[164:167], v[112:127]
    s_waitcnt lgkmcnt(0)
    v_mfma_f32_32x32x16_bf16 v[64:79], v[136:139], v[128:131], v[64:79]
    v_mfma_f32_32x32x16_bf16 v[80:95], v[136:139], v[132:135], v[80:95]
    v_mfma_f32_32x32x16_bf16 v[96:111], v[140:143], v[128:131], v[96:111]
    v_mfma_f32_32x32x16_bf16 v[112:127], v[140:143], v[132:135], v[112:127]
    s_waitcnt vmcnt(6)
    s_barrier
    s_mov_b32 s47, 384
    s_mov_b32 s48, 1572864
    s_add_u32 m0, s51, 0
    s_nop 0
    buffer_load_dwordx4 v10, s[12:15], s47 offen lds
    s_add_u32 m0, s51, 8192
    s_nop 0
    buffer_load_dwordx4 v11, s[12:15], s47 offen lds
    s_add_u32 m0, s51, 16384
    s_nop 0
    buffer_load_dwordx4 v13, s[16:19], s48 offen lds
    s_add_u32 m0, s51, 24576
    s_nop 0
    buffer_load_dwordx4 v14, s[16:19], s48 offen lds
    s_add_u32 m0, s51, 32768
    s_nop 0
    buffer_load_dwordx4 v15, s[16:19], s48 offen lds
    s_add_u32 m0, s51, 40960
    s_nop 0
    buffer_load_dwordx4 v16, s[16:19], s48 offen lds
    ds_read_b128 v[128:131], v28 offset:0
    ds_read_b128 v[132:135], v28 offset:4096
    ds_read_b64_tr_b16 v[136:137], v32 offset:0
    ds_read_b64_tr_b16 v[138:139], v32 offset:2048
    ds_read_b64_tr_b16 v[140:141], v33 offset:0
    ds_read_b64_tr_b16 v[142:143], v33 offset:2048
    ds_read_b128 v[144:147], v29 offset:0
    ds_read_b128 v[148:151], v29 offset:4096
    ds_read_b64_tr_b16 v[152:153], v32 offset:8192
    ds_read_b64_tr_b16 v[154:155], v32 offset:10240
    ds_read_b64_tr_b16 v[156:157], v33 offset:8192
    ds_read_b64_tr_b16 v[158:159], v33 offset:10240
    ds_read_b128 v[160:163], v30 offset:0
    ds_read_b128 v[164:167], v30 offset:4096
    ds_read_b64_tr_b16 v[168:169], v32 offset:16384
    ds_read_b64_tr_b16 v[170:171], v32 offset:18432
    ds_read_b64_tr_b16 v[172:173], v33 offset:16384
    ds_read_b64_tr_b16 v[174:175], v33 offset:18432
    s_waitcnt lgkmcnt(12)
    v_mfma_f32_32x32x16_bf16 v[64:79], v[136:139], v[128:131], v[64:79]
    v_mfma_f32_32x32x16_bf16 v[80:95], v[136:139], v[132:135], v[80:95]
    v_mfma_f32_32x32x16_bf16 v[96:111], v[140:143], v[128:131], v[96:111]
    v_mfma_f32_32x32x16_bf16 v[112:127], v[140:143], v[132:135], v[112:127]
    ds_read_b128 v[128:131], v31 offset:0
    ds_read_b128 v[132:135], v31 offset:4096
    ds_read_b64_tr_b16 v[136:137], v32 offset:24576
    ds_read_b64_tr_b16 v[138:139], v32 offset:26624
    ds_read_b64_tr_b16 v[140:141], v33 offset:24576
    ds_read_b64_tr_b16 v[142:143], v33 offset:26624
    s_waitcnt lgkmcnt(12)
    v_mfma_f32_32x32x16_bf16 v[64:79], v[152:155], v[144:147], v[64:79]
    v_mfma_f32_32x32x16_bf16 v[80:95], v[152:155], v[148:151], v[80:95]
    v_mfma_f32_32x32x16_bf16 v[96:111], v[156:159], v[144:147], v[96:111]
    v_mfma_f32_32x32x16_bf16 v[112:127], v[156:159], v[148:151], v[112:127]
    s_waitcnt lgkmcnt(6)
    v_mfma_f32_32x32x16_bf16 v[64:79], v[168:171], v[160:163], v[64:79]
    v_mfma_f32_32x32x16_bf16 v[80:95], v[168:171], v[164:167], v[80:95]
    v_mfma_f32_32x32x16_bf16 v[96:111], v[172:175], v[160:163], v[96:111]
    v_mfma_f32_32x32x16_bf16 v[112:127], v[172:175], v[164:167], v[112:127]
    s_waitcnt lgkmcnt(0)
    v_mfma_f32_32x32x16_bf16 v[64:79], v[136:139], v[128:131], v[64:79]
    v_mfma_f32_32x32x16_bf16 v[80:95], v[136:139], v[132:135], v[80:95]
    v_mfma_f32_32x32x16_bf16 v[96:111], v[140:143], v[128:131], v[96:111]
    v_mfma_f32_32x32x16_bf16 v[112:127], v[140:143], v[132:135], v[112:127]
    s_waitcnt vmcnt(6)
    s_barrier
    s_mov_b32 s47, 512
    s_mov_b32 s48, 2097152
    s_add_u32 m0, s51, 49152
    s_nop 0
    buffer_load_dwordx4 v10, s[12:15], s47 offen lds
    s_add_u32 m0, s51, 57344
    s_nop 0
    buffer_load_dwordx4 v11, s[12:15], s47 offen lds
    s_add_u32 m0, s51, 65536
    s_nop 0
    buffer_load_dwordx4 v13, s[16:19], s48 offen lds
    s_add_u32 m0, s51, 73728
    s_nop 0
    buffer_load_dwordx4 v14, s[16:19], s48 offen lds
    s_add_u32 m0, s51, 81920
    s_nop 0
    buffer_load_dwordx4 v15, s[16:19], s48 offen lds
    s_add_u32 m0, s51, 90112
    s_nop 0
    buffer_load_dwordx4 v16, s[16:19], s48 offen lds
    ds_read_b128 v[128:131], v36 offset:0
    ds_read_b128 v[132:135], v36 offset:4096
    ds_read_b64_tr_b16 v[136:137], v40 offset:0
    ds_read_b64_tr_b16 v[138:139], v40 offset:2048
    ds_read_b64_tr_b16 v[140:141], v41 offset:0
    ds_read_b64_tr_b16 v[142:143], v41 offset:2048
    ds_read_b128 v[144:147], v37 offset:0
    ds_read_b128 v[148:151], v37 offset:4096
    ds_read_b64_tr_b16 v[152:153], v40 offset:8192
    ds_read_b64_tr_b16 v[154:155], v40 offset:10240
    ds_read_b64_tr_b16 v[156:157], v41 offset:8192
    ds_read_b64_tr_b16 v[158:159], v41 offset:10240
    ds_read_b128 v[160:163], v38 offset:0
    ds_read_b128 v[164:167], v38 offset:4096
    ds_read_b64_tr_b16 v[168:169], v40 offset:16384
    ds_read_b64_tr_b16 v[170:171], v40 offset:18432
    ds_read_b64_tr_b16 v[172:173], v41 offset:16384
    ds_read_b64_tr_b16 v[174:175], v41 offset:18432
    s_waitcnt lgkmcnt(12)
    v_mfma_f32_32x32x16_bf16 v[64:79], v[136:139], v[128:131], v[64:79]
    v_mfma_f32_32x32x16_bf16 v[80:95], v[136:139], v[132:135], v[80:95]
    v_mfma_f32_32x32x16_bf16 v[96:111], v[140:143], v[128:131], v[96:111]
    v_mfma_f32_32x32x16_bf16 v[112:127], v[140:143], v[132:135], v[112:127]
    ds_read_b128 v[128:131], v39 offset:0
    ds_read_b128 v[132:135], v39 offset:4096
    ds_read_b64_tr_b16 v[136:137], v40 offset:24576
    ds_read_b64_tr_b16 v[138:139], v40 offset:26624
    ds_read_b64_tr_b16 v[140:141], v41 offset:24576
    ds_read_b64_tr_b16 v[142:143], v41 offset:26624
    s_waitcnt lgkmcnt(12)
    v_mfma_f32_32x32x16_bf16 v[64:79], v[152:155], v[144:147], v[64:79]
    v_mfma_f32_32x32x16_bf16 v[80:95], v[152:155], v[148:151], v[80:95]
    v_mfma_f32_32x32x16_bf16 v[96:111], v[156:159], v[144:147], v[96:111]
    v_mfma_f32_32x32x16_bf16 v[112:127], v[156:159], v[148:151], v[112:127]
    s_waitcnt lgkmcnt(6)
    v_mfma_f32_32x32x16_bf16 v[64:79], v[168:171], v[160:163], v[64:79]
    v_mfma_f32_32x32x16_bf16 v[80:95], v[168:171], v[164:167], v[80:95]
    v_mfma_f32_32x32x16_bf16 v[96:111], v[172:175], v[160:163], v[96:111]
    v_mfma_f32_32x32x16_bf16 v[112:127], v[172:175], v[164:167], v[112:127]
    s_waitcnt lgkmcnt(0)
    v_mfma_f32_32x32x16_bf16 v[64:79], v[136:139], v[128:131], v[64:79]
    v_mfma_f32_32x32x16_bf16 v[80:95], v[136:139], v[132:135], v[80:95]
    v_mfma_f32_32x32x16_bf16 v[96:111], v[140:143], v[128:131], v[96:111]
    v_mfma_f32_32x32x16_bf16 v[112:127], v[140:143], v[132:135], v[112:127]
    s_waitcnt vmcnt(6)
    s_barrier
    s_mov_b32 s47, 640
    s_mov_b32 s48, 2621440
    s_add_u32 m0, s51, 98304
    s_nop 0
    buffer_load_dwordx4 v10, s[12:15], s47 offen lds
    s_add_u32 m0, s51, 106496
    s_nop 0
    buffer_load_dwordx4 v11, s[12:15], s47 offen lds
    s_add_u32 m0, s51, 114688
    s_nop 0
    buffer_load_dwordx4 v13, s[16:19], s48 offen lds
    s_add_u32 m0, s51, 122880
    s_nop 0
    buffer_load_dwordx4 v14, s[16:19], s48 offen lds
    s_add_u32 m0, s51, 131072
    s_nop 0
    buffer_load_dwordx4 v15, s[16:19], s48 offen lds
    s_add_u32 m0, s51, 139264
    s_nop 0
    buffer_load_dwordx4 v16, s[16:19], s48 offen lds
    ds_read_b128 v[128:131], v20 offset:0
    ds_read_b128 v[132:135], v20 offset:4096
    ds_read_b64_tr_b16 v[136:137], v24 offset:0
    ds_read_b64_tr_b16 v[138:139], v24 offset:2048
    ds_read_b64_tr_b16 v[140:141], v25 offset:0
    ds_read_b64_tr_b16 v[142:143], v25 offset:2048
    ds_read_b128 v[144:147], v21 offset:0
    ds_read_b128 v[148:151], v21 offset:4096
    ds_read_b64_tr_b16 v[152:153], v24 offset:8192
    ds_read_b64_tr_b16 v[154:155], v24 offset:10240
    ds_read_b64_tr_b16 v[156:157], v25 offset:8192
    ds_read_b64_tr_b16 v[158:159], v25 offset:10240
    ds_read_b128 v[160:163], v22 offset:0
    ds_read_b128 v[164:167], v22 offset:4096
    ds_read_b64_tr_b16 v[168:169], v24 offset:16384
    ds_read_b64_tr_b16 v[170:171], v24 offset:18432
    ds_read_b64_tr_b16 v[172:173], v25 offset:16384
    ds_read_b64_tr_b16 v[174:175], v25 offset:18432
    s_waitcnt lgkmcnt(12)
    v_mfma_f32_32x32x16_bf16 v[64:79], v[136:139], v[128:131], v[64:79]
    v_mfma_f32_32x32x16_bf16 v[80:95], v[136:139], v[132:135], v[80:95]
    v_mfma_f32_32x32x16_bf16 v[96:111], v[140:143], v[128:131], v[96:111]
    v_mfma_f32_32x32x16_bf16 v[112:127], v[140:143], v[132:135], v[112:127]
    ds_read_b128 v[128:131], v23 offset:0
    ds_read_b128 v[132:135], v23 offset:4096
    ds_read_b64_tr_b16 v[136:137], v24 offset:24576
    ds_read_b64_tr_b16 v[138:139], v24 offset:26624
    ds_read_b64_tr_b16 v[140:141], v25 offset:24576
    ds_read_b64_tr_b16 v[142:143], v25 offset:26624
    s_waitcnt lgkmcnt(12)
    v_mfma_f32_32x32x16_bf16 v[64:79], v[152:155], v[144:147], v[64:79]
    v_mfma_f32_32x32x16_bf16 v[80:95], v[152:155], v[148:151], v[80:95]
    v_mfma_f32_32x32x16_bf16 v[96:111], v[156:159], v[144:147], v[96:111]
    v_mfma_f32_32x32x16_bf16 v[112:127], v[156:159], v[148:151], v[112:127]
    s_waitcnt lgkmcnt(6)
    v_mfma_f32_32x32x16_bf16 v[64:79], v[168:171], v[160:163], v[64:79]
    v_mfma_f32_32x32x16_bf16 v[80:95], v[168:171], v[164:167], v[80:95]
    v_mfma_f32_32x32x16_bf16 v[96:111], v[172:175], v[160:163], v[96:111]
    v_mfma_f32_32x32x16_bf16 v[112:127], v[172:175], v[164:167], v[112:127]
    s_waitcnt lgkmcnt(0)
    v_mfma_f32_32x32x16_bf16 v[64:79], v[136:139], v[128:131], v[64:79]
    v_mfma_f32_32x32x16_bf16 v[80:95], v[136:139], v[132:135], v[80:95]
    v_mfma_f32_32x32x16_bf16 v[96:111], v[140:143], v[128:131], v[96:111]
    v_mfma_f32_32x32x16_bf16 v[112:127], v[140:143], v[132:135], v[112:127]
    s_waitcnt vmcnt(6)
    s_barrier
    s_mov_b32 s47, 768
    s_mov_b32 s48, 3145728
    s_add_u32 m0, s51, 0
    s_nop 0
    buffer_load_dwordx4 v10, s[12:15], s47 offen lds
    s_add_u32 m0, s51, 8192
    s_nop 0
    buffer_load_dwordx4 v11, s[12:15], s47 offen lds
    s_add_u32 m0, s51, 16384
    s_nop 0
    buffer_load_dwordx4 v13, s[16:19], s48 offen lds
    s_add_u32 m0, s51, 24576
    s_nop 0
    buffer_load_dwordx4 v14, s[16:19], s48 offen lds
    s_add_u32 m0, s51, 32768
    s_nop 0
    buffer_load_dwordx4 v15, s[16:19], s48 offen lds
    s_add_u32 m0, s51, 40960
    s_nop 0
    buffer_load_dwordx4 v16, s[16:19], s48 offen lds
    ds_read_b128 v[128:131], v28 offset:0
    ds_read_b128 v[132:135], v28 offset:4096
    ds_read_b64_tr_b16 v[136:137], v32 offset:0
    ds_read_b64_tr_b16 v[138:139], v32 offset:2048
    ds_read_b64_tr_b16 v[140:141], v33 offset:0
    ds_read_b64_tr_b16 v[142:143], v33 offset:2048
    ds_read_b128 v[144:147], v29 offset:0
    ds_read_b128 v[148:151], v29 offset:4096
    ds_read_b64_tr_b16 v[152:153], v32 offset:8192
    ds_read_b64_tr_b16 v[154:155], v32 offset:10240
    ds_read_b64_tr_b16 v[156:157], v33 offset:8192
    ds_read_b64_tr_b16 v[158:159], v33 offset:10240
    ds_read_b128 v[160:163], v30 offset:0
    ds_read_b128 v[164:167], v30 offset:4096
    ds_read_b64_tr_b16 v[168:169], v32 offset:16384
    ds_read_b64_tr_b16 v[170:171], v32 offset:18432
    ds_read_b64_tr_b16 v[172:173], v33 offset:16384
    ds_read_b64_tr_b16 v[174:175], v33 offset:18432
    s_waitcnt lgkmcnt(12)
    v_mfma_f32_32x32x16_bf16 v[64:79], v[136:139], v[128:131], v[64:79]
    v_mfma_f32_32x32x16_bf16 v[80:95], v[136:139], v[132:135], v[80:95]
    v_mfma_f32_32x32x16_bf16 v[96:111], v[140:143], v[128:131], v[96:111]
    v_mfma_f32_32x32x16_bf16 v[112:127], v[140:143], v[132:135], v[112:127]
    ds_read_b128 v[128:131], v31 offset:0
    ds_read_b128 v[132:135], v31 offset:4096
    ds_read_b64_tr_b16 v[136:137], v32 offset:24576
    ds_read_b64_tr_b16 v[138:139], v32 offset:26624
    ds_read_b64_tr_b16 v[140:141], v33 offset:24576
    ds_read_b64_tr_b16 v[142:143], v33 offset:26624
    s_waitcnt lgkmcnt(12)
    v_mfma_f32_32x32x16_bf16 v[64:79], v[152:155], v[144:147], v[64:79]
    v_mfma_f32_32x32x16_bf16 v[80:95], v[152:155], v[148:151], v[80:95]
    v_mfma_f32_32x32x16_bf16 v[96:111], v[156:159], v[144:147], v[96:111]
    v_mfma_f32_32x32x16_bf16 v[112:127], v[156:159], v[148:151], v[112:127]
    s_waitcnt lgkmcnt(6)
    v_mfma_f32_32x32x16_bf16 v[64:79], v[168:171], v[160:163], v[64:79]
    v_mfma_f32_32x32x16_bf16 v[80:95], v[168:171], v[164:167], v[80:95]
    v_mfma_f32_32x32x16_bf16 v[96:111], v[172:175], v[160:163], v[96:111]
    v_mfma_f32_32x32x16_bf16 v[112:127], v[172:175], v[164:167], v[112:127]
    s_waitcnt lgkmcnt(0)
    v_mfma_f32_32x32x16_bf16 v[64:79], v[136:139], v[128:131], v[64:79]
    v_mfma_f32_32x32x16_bf16 v[80:95], v[136:139], v[132:135], v[80:95]
    v_mfma_f32_32x32x16_bf16 v[96:111], v[140:143], v[128:131], v[96:111]
    v_mfma_f32_32x32x16_bf16 v[112:127], v[140:143], v[132:135], v[112:127]
    s_waitcnt vmcnt(6)
    s_barrier
    s_mov_b32 s47, 896
    s_mov_b32 s48, 3670016
    s_add_u32 m0, s51, 49152
    s_nop 0
    buffer_load_dwordx4 v10, s[12:15], s47 offen lds
    s_add_u32 m0, s51, 57344
    s_nop 0
    buffer_load_dwordx4 v11, s[12:15], s47 offen lds
    s_add_u32 m0, s51, 65536
    s_nop 0
    buffer_load_dwordx4 v13, s[16:19], s48 offen lds
    s_add_u32 m0, s51, 73728
    s_nop 0
    buffer_load_dwordx4 v14, s[16:19], s48 offen lds
    s_add_u32 m0, s51, 81920
    s_nop 0
    buffer_load_dwordx4 v15, s[16:19], s48 offen lds
    s_add_u32 m0, s51, 90112
    s_nop 0
    buffer_load_dwordx4 v16, s[16:19], s48 offen lds
    ds_read_b128 v[128:131], v36 offset:0
    ds_read_b128 v[132:135], v36 offset:4096
    ds_read_b64_tr_b16 v[136:137], v40 offset:0
    ds_read_b64_tr_b16 v[138:139], v40 offset:2048
    ds_read_b64_tr_b16 v[140:141], v41 offset:0
    ds_read_b64_tr_b16 v[142:143], v41 offset:2048
    ds_read_b128 v[144:147], v37 offset:0
    ds_read_b128 v[148:151], v37 offset:4096
    ds_read_b64_tr_b16 v[152:153], v40 offset:8192
    ds_read_b64_tr_b16 v[154:155], v40 offset:10240
    ds_read_b64_tr_b16 v[156:157], v41 offset:8192
    ds_read_b64_tr_b16 v[158:159], v41 offset:10240
    ds_read_b128 v[160:163], v38 offset:0
    ds_read_b128 v[164:167], v38 offset:4096
    ds_read_b64_tr_b16 v[168:169], v40 offset:16384
    ds_read_b64_tr_b16 v[170:171], v40 offset:18432
    ds_read_b64_tr_b16 v[172:173], v41 offset:16384
    ds_read_b64_tr_b16 v[174:175], v41 offset:18432
    s_waitcnt lgkmcnt(12)
    v_mfma_f32_32x32x16_bf16 v[64:79], v[136:139], v[128:131], v[64:79]
    v_mfma_f32_32x32x16_bf16 v[80:95], v[136:139], v[132:135], v[80:95]
    v_mfma_f32_32x32x16_bf16 v[96:111], v[140:143], v[128:131], v[96:111]
    v_mfma_f32_32x32x16_bf16 v[112:127], v[140:143], v[132:135], v[112:127]
    ds_read_b128 v[128:131], v39 offset:0
    ds_read_b128 v[132:135], v39 offset:4096
    ds_read_b64_tr_b16 v[136:137], v40 offset:24576
    ds_read_b64_tr_b16 v[138:139], v40 offset:26624
    ds_read_b64_tr_b16 v[140:141], v41 offset:24576
    ds_read_b64_tr_b16 v[142:143], v41 offset:26624
    s_waitcnt lgkmcnt(12)
    v_mfma_f32_32x32x16_bf16 v[64:79], v[152:155], v[144:147], v[64:79]
    v_mfma_f32_32x32x16_bf16 v[80:95], v[152:155], v[148:151], v[80:95]
    v_mfma_f32_32x32x16_bf16 v[96:111], v[156:159], v[144:147], v[96:111]
    v_mfma_f32_32x32x16_bf16 v[112:127], v[156:159], v[148:151], v[112:127]
    s_waitcnt lgkmcnt(6)
    v_mfma_f32_32x32x16_bf16 v[64:79], v[168:171], v[160:163], v[64:79]
    v_mfma_f32_32x32x16_bf16 v[80:95], v[168:171], v[164:167], v[80:95]
    v_mfma_f32_32x32x16_bf16 v[96:111], v[172:175], v[160:163], v[96:111]
    v_mfma_f32_32x32x16_bf16 v[112:127], v[172:175], v[164:167], v[112:127]
    s_waitcnt lgkmcnt(0)
    v_mfma_f32_32x32x16_bf16 v[64:79], v[136:139], v[128:131], v[64:79]
    v_mfma_f32_32x32x16_bf16 v[80:95], v[136:139], v[132:135], v[80:95]
    v_mfma_f32_32x32x16_bf16 v[96:111], v[140:143], v[128:131], v[96:111]
    v_mfma_f32_32x32x16_bf16 v[112:127], v[140:143], v[132:135], v[112:127]
    s_waitcnt vmcnt(6)
    s_barrier
    ds_read_b128 v[128:131], v20 offset:0
    ds_read_b128 v[132:135], v20 offset:4096
    ds_read_b64_tr_b16 v[136:137], v24 offset:0
    ds_read_b64_tr_b16 v[138:139], v24 offset:2048
    ds_read_b64_tr_b16 v[140:141], v25 offset:0
    ds_read_b64_tr_b16 v[142:143], v25 offset:2048
    ds_read_b128 v[144:147], v21 offset:0
    ds_read_b128 v[148:151], v21 offset:4096
    ds_read_b64_tr_b16 v[152:153], v24 offset:8192
    ds_read_b64_tr_b16 v[154:155], v24 offset:10240
    ds_read_b64_tr_b16 v[156:157], v25 offset:8192
    ds_read_b64_tr_b16 v[158:159], v25 offset:10240
    ds_read_b128 v[160:163], v22 offset:0
    ds_read_b128 v[164:167], v22 offset:4096
    ds_read_b64_tr_b16 v[168:169], v24 offset:16384
    ds_read_b64_tr_b16 v[170:171], v24 offset:18432
    ds_read_b64_tr_b16 v[172:173], v25 offset:16384
    ds_read_b64_tr_b16 v[174:175], v25 offset:18432
    s_waitcnt lgkmcnt(12)
    v_mfma_f32_32x32x16_bf16 v[64:79], v[136:139], v[128:131], v[64:79]
    v_mfma_f32_32x32x16_bf16 v[80:95], v[136:139], v[132:135], v[80:95]
    v_mfma_f32_32x32x16_bf16 v[96:111], v[140:143], v[128:131], v[96:111]
    v_mfma_f32_32x32x16_bf16 v[112:127], v[140:143], v[132:135], v[112:127]
    ds_read_b128 v[128:131], v23 offset:0
    ds_read_b128 v[132:135], v23 offset:4096
    ds_read_b64_tr_b16 v[136:137], v24 offset:24576
    ds_read_b64_tr_b16 v[138:139], v24 offset:26624
    ds_read_b64_tr_b16 v[140:141], v25 offset:24576
    ds_read_b64_tr_b16 v[142:143], v25 offset:26624
    s_waitcnt lgkmcnt(12)
    v_mfma_f32_32x32x16_bf16 v[64:79], v[152:155], v[144:147], v[64:79]
    v_mfma_f32_32x32x16_bf16 v[80:95], v[152:155], v[148:151], v[80:95]
    v_mfma_f32_32x32x16_bf16 v[96:111], v[156:159], v[144:147], v[96:111]
    v_mfma_f32_32x32x16_bf16 v[112:127], v[156:159], v[148:151], v[112:127]
    s_waitcnt lgkmcnt(6)
    v_mfma_f32_32x32x16_bf16 v[64:79], v[168:171], v[160:163], v[64:79]
    v_mfma_f32_32x32x16_bf16 v[80:95], v[168:171], v[164:167], v[80:95]
    v_mfma_f32_32x32x16_bf16 v[96:111], v[172:175], v[160:163], v[96:111]
    v_mfma_f32_32x32x16_bf16 v[112:127], v[172:175], v[164:167], v[112:127]
    s_waitcnt lgkmcnt(0)
    v_mfma_f32_32x32x16_bf16 v[64:79], v[136:139], v[128:131], v[64:79]
    v_mfma_f32_32x32x16_bf16 v[80:95], v[136:139], v[132:135], v[80:95]
    v_mfma_f32_32x32x16_bf16 v[96:111], v[140:143], v[128:131], v[96:111]
    v_mfma_f32_32x32x16_bf16 v[112:127], v[140:143], v[132:135], v[112:127]
    s_waitcnt vmcnt(0)
    s_barrier
    ds_read_b128 v[128:131], v28 offset:0
    ds_read_b128 v[132:135], v28 offset:4096
    ds_read_b64_tr_b16 v[136:137], v32 offset:0
    ds_read_b64_tr_b16 v[138:139], v32 offset:2048
    ds_read_b64_tr_b16 v[140:141], v33 offset:0
    ds_read_b64_tr_b16 v[142:143], v33 offset:2048
    ds_read_b128 v[144:147], v29 offset:0
    ds_read_b128 v[148:151], v29 offset:4096
    ds_read_b64_tr_b16 v[152:153], v32 offset:8192
    ds_read_b64_tr_b16 v[154:155], v32 offset:10240
    ds_read_b64_tr_b16 v[156:157], v33 offset:8192
    ds_read_b64_tr_b16 v[158:159], v33 offset:10240
    ds_read_b128 v[160:163], v30 offset:0
    ds_read_b128 v[164:167], v30 offset:4096
    ds_read_b64_tr_b16 v[168:169], v32 offset:16384
    ds_read_b64_tr_b16 v[170:171], v32 offset:18432
    ds_read_b64_tr_b16 v[172:173], v33 offset:16384
    ds_read_b64_tr_b16 v[174:175], v33 offset:18432
    s_waitcnt lgkmcnt(12)
    v_mfma_f32_32x32x16_bf16 v[64:79], v[136:139], v[128:131], v[64:79]
    v_mfma_f32_32x32x16_bf16 v[80:95], v[136:139], v[132:135], v[80:95]
    v_mfma_f32_32x32x16_bf16 v[96:111], v[140:143], v[128:131], v[96:111]
    v_mfma_f32_32x32x16_bf16 v[112:127], v[140:143], v[132:135], v[112:127]
    ds_read_b128 v[128:131], v31 offset:0
    ds_read_b128 v[132:135], v31 offset:4096
    ds_read_b64_tr_b16 v[136:137], v32 offset:24576
    ds_read_b64_tr_b16 v[138:139], v32 offset:26624
    ds_read_b64_tr_b16 v[140:141], v33 offset:24576
    ds_read_b64_tr_b16 v[142:143], v33 offset:26624
    s_waitcnt lgkmcnt(12)
    v_mfma_f32_32x32x16_bf16 v[64:79], v[152:155], v[144:147], v[64:79]
    v_mfma_f32_32x32x16_bf16 v[80:95], v[152:155], v[148:151], v[80:95]
    v_mfma_f32_32x32x16_bf16 v[96:111], v[156:159], v[144:147], v[96:111]
    v_mfma_f32_32x32x16_bf16 v[112:127], v[156:159], v[148:151], v[112:127]
    s_waitcnt lgkmcnt(6)
    v_mfma_f32_32x32x16_bf16 v[64:79], v[168:171], v[160:163], v[64:79]
    v_mfma_f32_32x32x16_bf16 v[80:95], v[168:171], v[164:167], v[80:95]
    v_mfma_f32_32x32x16_bf16 v[96:111], v[172:175], v[160:163], v[96:111]
    v_mfma_f32_32x32x16_bf16 v[112:127], v[172:175], v[164:167], v[112:127]
    s_waitcnt lgkmcnt(0)
    v_mfma_f32_32x32x16_bf16 v[64:79], v[136:139], v[128:131], v[64:79]
    v_mfma_f32_32x32x16_bf16 v[80:95], v[136:139], v[132:135], v[80:95]
    v_mfma_f32_32x32x16_bf16 v[96:111], v[140:143], v[128:131], v[96:111]
    v_mfma_f32_32x32x16_bf16 v[112:127], v[140:143], v[132:135], v[112:127]
    s_nop 7
    s_nop 7
    v_and_b32 v3, 31, v1
    v_and_b32 v4, 1, v2
    v_lshlrev_b32 v4, 6, v4
    v_add_u32 v4, v4, v3
    s_lshl_b32 s44, s40, 7
    v_add_u32 v4, s44, v4
    v_lshrrev_b32 v5, 5, v1
    v_lshlrev_b32 v5, 2, v5
    v_lshrrev_b32 v6, 1, v2
    s_add_u32 s24, s8, 1048576
    s_addc_u32 s25, s9, 0
    s_mov_b32 s26, 16777216
    s_mov_b32 s27, 0x00020000
    v_lshlrev_b32 v6, 6, v6
    v_add_u32 v5, v5, v6
    s_lshl_b32 s46, s42, 8
    v_add_u32 v5, s46, v5
    s_mov_b32 s45, 4096
    v_mul_lo_u32 v4, v4, s45
    v_add_u32 v4, v4, v5
    v_lshlrev_b32 v4, 1, v4
    v_add_u32 v5, 262144, v4
    v_cvt_pk_bf16_f32 v64, v64, v64
    v_lshlrev_b32 v64, 16, v64
    v_mul_f32 v64, 0x3e0293ee, v64
    v_cvt_pk_bf16_f32 v65, v65, v65
    v_lshlrev_b32 v65, 16, v65
    v_mul_f32 v65, 0x3e0293ee, v65
    v_cvt_pk_bf16_f32 v66, v66, v66
    v_lshlrev_b32 v66, 16, v66
    v_mul_f32 v66, 0x3e0293ee, v66
    v_cvt_pk_bf16_f32 v67, v67, v67
    v_lshlrev_b32 v67, 16, v67
    v_mul_f32 v67, 0x3e0293ee, v67
    v_cvt_pk_bf16_f32 v8, v64, v65
    v_cvt_pk_bf16_f32 v9, v66, v67
    buffer_store_dwordx2 v[8:9], v4, s[24:27], 0 offen offset:0
    s_nop 1
    v_cvt_pk_bf16_f32 v68, v68, v68
    v_lshlrev_b32 v68, 16, v68
    v_mul_f32 v68, 0x3e0293ee, v68
    v_cvt_pk_bf16_f32 v69, v69, v69
    v_lshlrev_b32 v69, 16, v69
    v_mul_f32 v69, 0x3e0293ee, v69
    v_cvt_pk_bf16_f32 v70, v70, v70
    v_lshlrev_b32 v70, 16, v70
    v_mul_f32 v70, 0x3e0293ee, v70
    v_cvt_pk_bf16_f32 v71, v71, v71
    v_lshlrev_b32 v71, 16, v71
    v_mul_f32 v71, 0x3e0293ee, v71
    v_cvt_pk_bf16_f32 v8, v68, v69
    v_cvt_pk_bf16_f32 v9, v70, v71
    buffer_store_dwordx2 v[8:9], v4, s[24:27], 0 offen offset:16
    s_nop 1
    v_cvt_pk_bf16_f32 v72, v72, v72
    v_lshlrev_b32 v72, 16, v72
    v_mul_f32 v72, 0x3e0293ee, v72
    v_cvt_pk_bf16_f32 v73, v73, v73
    v_lshlrev_b32 v73, 16, v73
    v_mul_f32 v73, 0x3e0293ee, v73
    v_cvt_pk_bf16_f32 v74, v74, v74
    v_lshlrev_b32 v74, 16, v74
    v_mul_f32 v74, 0x3e0293ee, v74
    v_cvt_pk_bf16_f32 v75, v75, v75
    v_lshlrev_b32 v75, 16, v75
    v_mul_f32 v75, 0x3e0293ee, v75
    v_cvt_pk_bf16_f32 v8, v72, v73
    v_cvt_pk_bf16_f32 v9, v74, v75
    buffer_store_dwordx2 v[8:9], v4, s[24:27], 0 offen offset:32
    s_nop 1
    v_cvt_pk_bf16_f32 v76, v76, v76
    v_lshlrev_b32 v76, 16, v76
    v_mul_f32 v76, 0x3e0293ee, v76
    v_cvt_pk_bf16_f32 v77, v77, v77
    v_lshlrev_b32 v77, 16, v77
    v_mul_f32 v77, 0x3e0293ee, v77
    v_cvt_pk_bf16_f32 v78, v78, v78
    v_lshlrev_b32 v78, 16, v78
    v_mul_f32 v78, 0x3e0293ee, v78
    v_cvt_pk_bf16_f32 v79, v79, v79
    v_lshlrev_b32 v79, 16, v79
    v_mul_f32 v79, 0x3e0293ee, v79
    v_cvt_pk_bf16_f32 v8, v76, v77
    v_cvt_pk_bf16_f32 v9, v78, v79
    buffer_store_dwordx2 v[8:9], v4, s[24:27], 0 offen offset:48
    s_nop 1
    v_cvt_pk_bf16_f32 v80, v80, v80
    v_lshlrev_b32 v80, 16, v80
    v_mul_f32 v80, 0x3e0293ee, v80
    v_cvt_pk_bf16_f32 v81, v81, v81
    v_lshlrev_b32 v81, 16, v81
    v_mul_f32 v81, 0x3e0293ee, v81
    v_cvt_pk_bf16_f32 v82, v82, v82
    v_lshlrev_b32 v82, 16, v82
    v_mul_f32 v82, 0x3e0293ee, v82
    v_cvt_pk_bf16_f32 v83, v83, v83
    v_lshlrev_b32 v83, 16, v83
    v_mul_f32 v83, 0x3e0293ee, v83
    v_cvt_pk_bf16_f32 v8, v80, v81
    v_cvt_pk_bf16_f32 v9, v82, v83
    buffer_store_dwordx2 v[8:9], v5, s[24:27], 0 offen offset:0
    s_nop 1
    v_cvt_pk_bf16_f32 v84, v84, v84
    v_lshlrev_b32 v84, 16, v84
    v_mul_f32 v84, 0x3e0293ee, v84
    v_cvt_pk_bf16_f32 v85, v85, v85
    v_lshlrev_b32 v85, 16, v85
    v_mul_f32 v85, 0x3e0293ee, v85
    v_cvt_pk_bf16_f32 v86, v86, v86
    v_lshlrev_b32 v86, 16, v86
    v_mul_f32 v86, 0x3e0293ee, v86
    v_cvt_pk_bf16_f32 v87, v87, v87
    v_lshlrev_b32 v87, 16, v87
    v_mul_f32 v87, 0x3e0293ee, v87
    v_cvt_pk_bf16_f32 v8, v84, v85
    v_cvt_pk_bf16_f32 v9, v86, v87
    buffer_store_dwordx2 v[8:9], v5, s[24:27], 0 offen offset:16
    s_nop 1
    v_cvt_pk_bf16_f32 v88, v88, v88
    v_lshlrev_b32 v88, 16, v88
    v_mul_f32 v88, 0x3e0293ee, v88
    v_cvt_pk_bf16_f32 v89, v89, v89
    v_lshlrev_b32 v89, 16, v89
    v_mul_f32 v89, 0x3e0293ee, v89
    v_cvt_pk_bf16_f32 v90, v90, v90
    v_lshlrev_b32 v90, 16, v90
    v_mul_f32 v90, 0x3e0293ee, v90
    v_cvt_pk_bf16_f32 v91, v91, v91
    v_lshlrev_b32 v91, 16, v91
    v_mul_f32 v91, 0x3e0293ee, v91
    v_cvt_pk_bf16_f32 v8, v88, v89
    v_cvt_pk_bf16_f32 v9, v90, v91
    buffer_store_dwordx2 v[8:9], v5, s[24:27], 0 offen offset:32
    s_nop 1
    v_cvt_pk_bf16_f32 v92, v92, v92
    v_lshlrev_b32 v92, 16, v92
    v_mul_f32 v92, 0x3e0293ee, v92
    v_cvt_pk_bf16_f32 v93, v93, v93
    v_lshlrev_b32 v93, 16, v93
    v_mul_f32 v93, 0x3e0293ee, v93
    v_cvt_pk_bf16_f32 v94, v94, v94
    v_lshlrev_b32 v94, 16, v94
    v_mul_f32 v94, 0x3e0293ee, v94
    v_cvt_pk_bf16_f32 v95, v95, v95
    v_lshlrev_b32 v95, 16, v95
    v_mul_f32 v95, 0x3e0293ee, v95
    v_cvt_pk_bf16_f32 v8, v92, v93
    v_cvt_pk_bf16_f32 v9, v94, v95
    buffer_store_dwordx2 v[8:9], v5, s[24:27], 0 offen offset:48
    s_nop 1
    v_cvt_pk_bf16_f32 v96, v96, v96
    v_lshlrev_b32 v96, 16, v96
    v_mul_f32 v96, 0x3e0293ee, v96
    v_cvt_pk_bf16_f32 v97, v97, v97
    v_lshlrev_b32 v97, 16, v97
    v_mul_f32 v97, 0x3e0293ee, v97
    v_cvt_pk_bf16_f32 v98, v98, v98
    v_lshlrev_b32 v98, 16, v98
    v_mul_f32 v98, 0x3e0293ee, v98
    v_cvt_pk_bf16_f32 v99, v99, v99
    v_lshlrev_b32 v99, 16, v99
    v_mul_f32 v99, 0x3e0293ee, v99
    v_cvt_pk_bf16_f32 v8, v96, v97
    v_cvt_pk_bf16_f32 v9, v98, v99
    buffer_store_dwordx2 v[8:9], v4, s[24:27], 0 offen offset:64
    s_nop 1
    v_cvt_pk_bf16_f32 v100, v100, v100
    v_lshlrev_b32 v100, 16, v100
    v_mul_f32 v100, 0x3e0293ee, v100
    v_cvt_pk_bf16_f32 v101, v101, v101
    v_lshlrev_b32 v101, 16, v101
    v_mul_f32 v101, 0x3e0293ee, v101
    v_cvt_pk_bf16_f32 v102, v102, v102
    v_lshlrev_b32 v102, 16, v102
    v_mul_f32 v102, 0x3e0293ee, v102
    v_cvt_pk_bf16_f32 v103, v103, v103
    v_lshlrev_b32 v103, 16, v103
    v_mul_f32 v103, 0x3e0293ee, v103
    v_cvt_pk_bf16_f32 v8, v100, v101
    v_cvt_pk_bf16_f32 v9, v102, v103
    buffer_store_dwordx2 v[8:9], v4, s[24:27], 0 offen offset:80
    s_nop 1
    v_cvt_pk_bf16_f32 v104, v104, v104
    v_lshlrev_b32 v104, 16, v104
    v_mul_f32 v104, 0x3e0293ee, v104
    v_cvt_pk_bf16_f32 v105, v105, v105
    v_lshlrev_b32 v105, 16, v105
    v_mul_f32 v105, 0x3e0293ee, v105
    v_cvt_pk_bf16_f32 v106, v106, v106
    v_lshlrev_b32 v106, 16, v106
    v_mul_f32 v106, 0x3e0293ee, v106
    v_cvt_pk_bf16_f32 v107, v107, v107
    v_lshlrev_b32 v107, 16, v107
    v_mul_f32 v107, 0x3e0293ee, v107
    v_cvt_pk_bf16_f32 v8, v104, v105
    v_cvt_pk_bf16_f32 v9, v106, v107
    buffer_store_dwordx2 v[8:9], v4, s[24:27], 0 offen offset:96
    s_nop 1
    v_cvt_pk_bf16_f32 v108, v108, v108
    v_lshlrev_b32 v108, 16, v108
    v_mul_f32 v108, 0x3e0293ee, v108
    v_cvt_pk_bf16_f32 v109, v109, v109
    v_lshlrev_b32 v109, 16, v109
    v_mul_f32 v109, 0x3e0293ee, v109
    v_cvt_pk_bf16_f32 v110, v110, v110
    v_lshlrev_b32 v110, 16, v110
    v_mul_f32 v110, 0x3e0293ee, v110
    v_cvt_pk_bf16_f32 v111, v111, v111
    v_lshlrev_b32 v111, 16, v111
    v_mul_f32 v111, 0x3e0293ee, v111
    v_cvt_pk_bf16_f32 v8, v108, v109
    v_cvt_pk_bf16_f32 v9, v110, v111
    buffer_store_dwordx2 v[8:9], v4, s[24:27], 0 offen offset:112
    s_nop 1
    v_cvt_pk_bf16_f32 v112, v112, v112
    v_lshlrev_b32 v112, 16, v112
    v_mul_f32 v112, 0x3e0293ee, v112
    v_cvt_pk_bf16_f32 v113, v113, v113
    v_lshlrev_b32 v113, 16, v113
    v_mul_f32 v113, 0x3e0293ee, v113
    v_cvt_pk_bf16_f32 v114, v114, v114
    v_lshlrev_b32 v114, 16, v114
    v_mul_f32 v114, 0x3e0293ee, v114
    v_cvt_pk_bf16_f32 v115, v115, v115
    v_lshlrev_b32 v115, 16, v115
    v_mul_f32 v115, 0x3e0293ee, v115
    v_cvt_pk_bf16_f32 v8, v112, v113
    v_cvt_pk_bf16_f32 v9, v114, v115
    buffer_store_dwordx2 v[8:9], v5, s[24:27], 0 offen offset:64
    s_nop 1
    v_cvt_pk_bf16_f32 v116, v116, v116
    v_lshlrev_b32 v116, 16, v116
    v_mul_f32 v116, 0x3e0293ee, v116
    v_cvt_pk_bf16_f32 v117, v117, v117
    v_lshlrev_b32 v117, 16, v117
    v_mul_f32 v117, 0x3e0293ee, v117
    v_cvt_pk_bf16_f32 v118, v118, v118
    v_lshlrev_b32 v118, 16, v118
    v_mul_f32 v118, 0x3e0293ee, v118
    v_cvt_pk_bf16_f32 v119, v119, v119
    v_lshlrev_b32 v119, 16, v119
    v_mul_f32 v119, 0x3e0293ee, v119
    v_cvt_pk_bf16_f32 v8, v116, v117
    v_cvt_pk_bf16_f32 v9, v118, v119
    buffer_store_dwordx2 v[8:9], v5, s[24:27], 0 offen offset:80
    s_nop 1
    v_cvt_pk_bf16_f32 v120, v120, v120
    v_lshlrev_b32 v120, 16, v120
    v_mul_f32 v120, 0x3e0293ee, v120
    v_cvt_pk_bf16_f32 v121, v121, v121
    v_lshlrev_b32 v121, 16, v121
    v_mul_f32 v121, 0x3e0293ee, v121
    v_cvt_pk_bf16_f32 v122, v122, v122
    v_lshlrev_b32 v122, 16, v122
    v_mul_f32 v122, 0x3e0293ee, v122
    v_cvt_pk_bf16_f32 v123, v123, v123
    v_lshlrev_b32 v123, 16, v123
    v_mul_f32 v123, 0x3e0293ee, v123
    v_cvt_pk_bf16_f32 v8, v120, v121
    v_cvt_pk_bf16_f32 v9, v122, v123
    buffer_store_dwordx2 v[8:9], v5, s[24:27], 0 offen offset:96
    s_nop 1
    v_cvt_pk_bf16_f32 v124, v124, v124
    v_lshlrev_b32 v124, 16, v124
    v_mul_f32 v124, 0x3e0293ee, v124
    v_cvt_pk_bf16_f32 v125, v125, v125
    v_lshlrev_b32 v125, 16, v125
    v_mul_f32 v125, 0x3e0293ee, v125
    v_cvt_pk_bf16_f32 v126, v126, v126
    v_lshlrev_b32 v126, 16, v126
    v_mul_f32 v126, 0x3e0293ee, v126
    v_cvt_pk_bf16_f32 v127, v127, v127
    v_lshlrev_b32 v127, 16, v127
    v_mul_f32 v127, 0x3e0293ee, v127
    v_cvt_pk_bf16_f32 v8, v124, v125
    v_cvt_pk_bf16_f32 v9, v126, v127
    buffer_store_dwordx2 v[8:9], v5, s[24:27], 0 offen offset:112
    s_nop 1
qproj_kernel_done:
    s_endpgm
.globl attn_kernel
.p2align 8
.type attn_kernel,@function
attn_kernel:
    s_cmp_ge_u32 s2, 256
    s_cbranch_scc1 attn_kernel_done
    s_load_dwordx2 s[4:5], s[0:1], 8
    s_load_dwordx2 s[6:7], s[0:1], 16
    s_load_dwordx2 s[8:9], s[0:1], 104
    s_and_b32 s40, s2, 7
    s_lshr_b32 s41, s2, 3
    s_and_b32 s42, s41, 3
    s_lshr_b32 s43, s41, 2
    s_lshl_b32 s44, s40, 2
    s_add_u32 s44, s44, s42
    s_waitcnt lgkmcnt(0)
    s_lshl_b32 s45, s40, 19
    s_add_u32 s4, s4, s45
    s_addc_u32 s5, s5, 0
    s_add_u32 s6, s6, s45
    s_addc_u32 s7, s7, 0
    s_mov_b32 s12, s4
    s_mov_b32 s13, s5
    s_mov_b32 s14, 524288
    s_mov_b32 s15, 0x00020000
    s_mov_b32 s16, s6
    s_mov_b32 s17, s7
    s_mov_b32 s18, 524288
    s_mov_b32 s19, 0x00020000
    s_add_u32 s20, s8, 1048576
    s_addc_u32 s21, s9, 0
    s_mov_b32 s22, 16777216
    s_mov_b32 s23, 0x00020000
    s_add_u32 s24, s8, 17825792
    s_addc_u32 s25, s9, 0
    s_mov_b32 s26, 16777216
    s_mov_b32 s27, 0x00020000
    v_and_b32 v1, 63, v0
    v_lshrrev_b32 v2, 6, v0
    v_and_b32 v3, 31, v1
    v_lshrrev_b32 v4, 5, v1
    v_readfirstlane_b32 s50, v2
    v_lshlrev_b32 v5, 5, v2
    v_add_u32 v5, v5, v3
    s_lshl_b32 s45, s43, 8
    v_add_u32 v5, s45, v5
    v_lshlrev_b32 v5, 13, v5
    s_lshl_b32 s45, s44, 8
    v_add_u32 v5, s45, v5
    v_lshlrev_b32 v6, 4, v4
    v_add_u32 v6, v5, v6
    buffer_load_dwordx4 v[32:35], v6, s[20:23], 0 offen offset:0
    buffer_load_dwordx4 v[36:39], v6, s[20:23], 0 offen offset:32
    buffer_load_dwordx4 v[40:43], v6, s[20:23], 0 offen offset:64
    buffer_load_dwordx4 v[44:47], v6, s[20:23], 0 offen offset:96
    buffer_load_dwordx4 v[48:51], v6, s[20:23], 0 offen offset:128
    buffer_load_dwordx4 v[52:55], v6, s[20:23], 0 offen offset:160
    buffer_load_dwordx4 v[56:59], v6, s[20:23], 0 offen offset:192
    buffer_load_dwordx4 v[60:63], v6, s[20:23], 0 offen offset:224
    v_lshrrev_b32 v7, 4, v0
    v_and_b32 v8, 15, v0
    v_lshlrev_b32 v9, 8, v7
    v_lshlrev_b32 v10, 4, v8
    v_add_u32 v10, v9, v10
    v_add_u32 v6, 0x2000, v10
    v_and_b32 v11, 15, v7
    v_xor_b32 v11, v11, v8
    v_lshlrev_b32 v11, 4, v11
    v_add_u32 v11, v9, v11
    v_and_b32 v12, 3, v7
    v_lshlrev_b32 v12, 2, v12
    v_xor_b32 v12, v12, v8
    v_lshlrev_b32 v12, 4, v12
    v_add_u32 v12, v9, v12
    v_add_u32 v12, 0x4000, v12
    v_and_b32 v13, 15, v1
    v_lshlrev_b32 v14, 8, v3
    v_add_u32 v15, 0, v4
    v_xor_b32 v15, v15, v13
    v_lshlrev_b32 v15, 4, v15
    v_add_u32 v16, v14, v15
    v_add_u32 v15, 2, v4
    v_xor_b32 v15, v15, v13
    v_lshlrev_b32 v15, 4, v15
    v_add_u32 v17, v14, v15
    v_add_u32 v15, 4, v4
    v_xor_b32 v15, v15, v13
    v_lshlrev_b32 v15, 4, v15
    v_add_u32 v18, v14, v15
    v_add_u32 v15, 6, v4
    v_xor_b32 v15, v15, v13
    v_lshlrev_b32 v15, 4, v15
    v_add_u32 v19, v14, v15
    v_add_u32 v15, 8, v4
    v_xor_b32 v15, v15, v13
    v_lshlrev_b32 v15, 4, v15
    v_add_u32 v20, v14, v15
    v_add_u32 v15, 10, v4
    v_xor_b32 v15, v15, v13
    v_lshlrev_b32 v15, 4, v15
    v_add_u32 v21, v14, v15
    v_add_u32 v15, 12, v4
    v_xor_b32 v15, v15, v13
    v_lshlrev_b32 v15, 4, v15
    v_add_u32 v22, v14, v15
    v_add_u32 v15, 14, v4
    v_xor_b32 v15, v15, v13
    v_lshlrev_b32 v15, 4, v15
    v_add_u32 v23, v14, v15
    v_lshrrev_b32 v7, 4, v1
    v_and_b32 v8, 15, v1
    v_lshrrev_b32 v9, 2, v8
    v_lshlrev_b32 v13, 2, v4
    v_add_u32 v13, v13, v9
    v_lshlrev_b32 v13, 8, v13
    v_and_b32 v14, 1, v8
    v_lshlrev_b32 v14, 3, v14
    v_add_u32 v13, v13, v14
    v_add_u32 v13, 0x4000, v13
    v_and_b32 v14, 1, v7
    v_lshlrev_b32 v14, 1, v14
    v_and_b32 v15, 3, v8
    v_lshrrev_b32 v15, 1, v15
    v_add_u32 v14, v14, v15
    v_lshlrev_b32 v9, 2, v9
    v_add_u32 v15, 0, v14
    v_xor_b32 v15, v15, v9
    v_lshlrev_b32 v15, 4, v15
    v_add_u32 v24, v13, v15
    v_add_u32 v15, 4, v14
    v_xor_b32 v15, v15, v9
    v_lshlrev_b32 v15, 4, v15
    v_add_u32 v25, v13, v15
    v_add_u32 v15, 8, v14
    v_xor_b32 v15, v15, v9
    v_lshlrev_b32 v15, 4, v15
    v_add_u32 v26, v13, v15
    v_add_u32 v15, 12, v14
    v_xor_b32 v15, v15, v9
    v_lshlrev_b32 v15, 4, v15
    v_add_u32 v27, v13, v15
    v_mov_b32 v64, 0
    v_mov_b32 v65, 0
    v_mov_b32 v66, 0
    v_mov_b32 v67, 0
    v_mov_b32 v68, 0
    v_mov_b32 v69, 0
    v_mov_b32 v70, 0
    v_mov_b32 v71, 0
    v_mov_b32 v72, 0
    v_mov_b32 v73, 0
    v_mov_b32 v74, 0
    v_mov_b32 v75, 0
    v_mov_b32 v76, 0
    v_mov_b32 v77, 0
    v_mov_b32 v78, 0
    v_mov_b32 v79, 0
    v_mov_b32 v80, 0
    v_mov_b32 v81, 0
    v_mov_b32 v82, 0
    v_mov_b32 v83, 0
    v_mov_b32 v84, 0
    v_mov_b32 v85, 0
    v_mov_b32 v86, 0
    v_mov_b32 v87, 0
    v_mov_b32 v88, 0
    v_mov_b32 v89, 0
    v_mov_b32 v90, 0
    v_mov_b32 v91, 0
    v_mov_b32 v92, 0
    v_mov_b32 v93, 0
    v_mov_b32 v94, 0
    v_mov_b32 v95, 0
    v_mov_b32 v96, 0
    v_mov_b32 v97, 0
    v_mov_b32 v98, 0
    v_mov_b32 v99, 0
    v_mov_b32 v100, 0
    v_mov_b32 v101, 0
    v_mov_b32 v102, 0
    v_mov_b32 v103, 0
    v_mov_b32 v104, 0
    v_mov_b32 v105, 0
    v_mov_b32 v106, 0
    v_mov_b32 v107, 0
    v_mov_b32 v108, 0
    v_mov_b32 v109, 0
    v_mov_b32 v110, 0
    v_mov_b32 v111, 0
    v_mov_b32 v112, 0
    v_mov_b32 v113, 0
    v_mov_b32 v114, 0
    v_mov_b32 v115, 0
    v_mov_b32 v116, 0
    v_mov_b32 v117, 0
    v_mov_b32 v118, 0
    v_mov_b32 v119, 0
    v_mov_b32 v120, 0
    v_mov_b32 v121, 0
    v_mov_b32 v122, 0
    v_mov_b32 v123, 0
    v_mov_b32 v124, 0
    v_mov_b32 v125, 0
    v_mov_b32 v126, 0
    v_mov_b32 v127, 0
    v_mov_b32 v28, 0
    v_mov_b32 v29, 0
    v_mov_b32 v232, 0
    v_mov_b32 v233, 0
    v_mov_b32 v234, 0
    v_mov_b32 v235, 0
    v_mov_b32 v236, 0
    v_mov_b32 v237, 0
    v_mov_b32 v238, 0
    v_mov_b32 v239, 0
    v_mov_b32 v240, 0
    v_mov_b32 v241, 0
    v_mov_b32 v242, 0
    v_mov_b32 v243, 0
    v_mov_b32 v244, 0
    v_mov_b32 v245, 0
    v_mov_b32 v246, 0
    v_mov_b32 v247, 0
    s_mov_b32 s47, 0
    s_mov_b32 s48, 0
    buffer_load_dwordx4 v[160:163], v10, s[12:15], s47 offen
    buffer_load_dwordx4 v[164:167], v6, s[12:15], s47 offen
    s_waitcnt vmcnt(0)
    ds_write_b128 v11, v[160:163] offset:0
    ds_write_b128 v11, v[164:167] offset:8192
    s_mov_b32 s47, 16384
    buffer_load_dwordx4 v[160:163], v10, s[12:15], s47 offen
    buffer_load_dwordx4 v[164:167], v6, s[12:15], s47 offen
    buffer_load_dwordx4 v[168:171], v10, s[16:19], s48 offen
    buffer_load_dwordx4 v[172:175], v6, s[16:19], s48 offen
    s_waitcnt lgkmcnt(0)
    s_barrier
    s_cmp_lt_u32 s50, 4
    s_cbranch_scc1 attn_kernel_nostag
    s_barrier
attn_kernel_nostag:
    s_setprio 1
    ds_read_b128 v[192:195], v16 offset:0
    ds_read_b128 v[196:199], v17 offset:0
    ds_read_b128 v[200:203], v18 offset:0
    ds_read_b128 v[204:207], v19 offset:0
    ds_read_b128 v[208:211], v20 offset:0
    ds_read_b128 v[212:215], v21 offset:0
    ds_read_b128 v[216:219], v22 offset:0
    ds_read_b128 v[220:223], v23 offset:0
    ds_read_b128 v[224:227], v16 offset:8192
    s_waitcnt lgkmcnt(8)
    v_mfma_f32_32x32x16_bf16 v[128:143], v[192:195], v[32:35], v[232:247]
    ds_read_b128 v[228:231], v17 offset:8192
    s_waitcnt lgkmcnt(8)
    v_mfma_f32_32x32x16_bf16 v[128:143], v[196:199], v[36:39], v[128:143]
    ds_read_b128 v[192:195], v18 offset:8192
    s_waitcnt lgkmcnt(8)
    v_mfma_f32_32x32x16_bf16 v[128:143], v[200:203], v[40:43], v[128:143]
    ds_read_b128 v[196:199], v19 offset:8192
    s_waitcnt lgkmcnt(8)
    v_mfma_f32_32x32x16_bf16 v[128:143], v[204:207], v[44:47], v[128:143]
    ds_read_b128 v[200:203], v20 offset:8192
    s_waitcnt lgkmcnt(8)
    v_mfma_f32_32x32x16_bf16 v[128:143], v[208:211], v[48:51], v[128:143]
    ds_read_b128 v[204:207], v21 offset:8192
    s_waitcnt lgkmcnt(8)
    v_mfma_f32_32x32x16_bf16 v[128:143], v[212:215], v[52:55], v[128:143]
    ds_read_b128 v[208:211], v22 offset:8192
    s_waitcnt lgkmcnt(8)
    v_mfma_f32_32x32x16_bf16 v[128:143], v[216:219], v[56:59], v[128:143]
    ds_read_b128 v[212:215], v23 offset:8192
    s_waitcnt lgkmcnt(8)
    v_mfma_f32_32x32x16_bf16 v[128:143], v[220:223], v[60:63], v[128:143]
    s_waitcnt lgkmcnt(7)
    v_mfma_f32_32x32x16_bf16 v[144:159], v[224:227], v[32:35], v[232:247]
    s_waitcnt lgkmcnt(6)
    v_mfma_f32_32x32x16_bf16 v[144:159], v[228:231], v[36:39], v[144:159]
    s_waitcnt lgkmcnt(5)
    v_mfma_f32_32x32x16_bf16 v[144:159], v[192:195], v[40:43], v[144:159]
    s_waitcnt lgkmcnt(4)
    v_mfma_f32_32x32x16_bf16 v[144:159], v[196:199], v[44:47], v[144:159]
    s_waitcnt lgkmcnt(3)
    v_mfma_f32_32x32x16_bf16 v[144:159], v[200:203], v[48:51], v[144:159]
    s_waitcnt lgkmcnt(2)
    v_mfma_f32_32x32x16_bf16 v[144:159], v[204:207], v[52:55], v[144:159]
    s_waitcnt lgkmcnt(1)
    v_mfma_f32_32x32x16_bf16 v[144:159], v[208:211], v[56:59], v[144:159]
    s_waitcnt lgkmcnt(0)
    v_mfma_f32_32x32x16_bf16 v[144:159], v[212:215], v[60:63], v[144:159]
    s_setprio 0
    s_waitcnt vmcnt(0)
    ds_write_b128 v11, v[160:163] offset:32768
    ds_write_b128 v11, v[164:167] offset:40960
    ds_write_b128 v12, v[168:171] offset:32768
    ds_write_b128 v12, v[172:175] offset:40960
    s_waitcnt lgkmcnt(0)
    s_barrier
    s_add_u32 s47, s47, 16384
    s_add_u32 s48, s48, 16384
    buffer_load_dwordx4 v[160:163], v10, s[12:15], s47 offen
    buffer_load_dwordx4 v[164:167], v6, s[12:15], s47 offen
    buffer_load_dwordx4 v[168:171], v10, s[16:19], s48 offen
    buffer_load_dwordx4 v[172:175], v6, s[16:19], s48 offen
    s_nop 7
    v_max3_f32 v30, v128, v129, v130
    v_max3_f32 v31, v131, v132, v133
    v_max3_f32 v30, v30, v134, v135
    v_max3_f32 v31, v31, v136, v137
    v_max3_f32 v30, v30, v138, v139
    v_max3_f32 v31, v31, v140, v141
    v_max3_f32 v30, v30, v142, v143
    v_max3_f32 v31, v31, v144, v145
    v_max3_f32 v30, v30, v146, v147
    v_max3_f32 v31, v31, v148, v149
    v_max3_f32 v30, v30, v150, v151
    v_max3_f32 v31, v31, v152, v153
    v_max3_f32 v30, v30, v154, v155
    v_max3_f32 v31, v31, v156, v157
    v_max3_f32 v30, v30, v158, v159
    v_max_f32 v30, v30, v31
    v_mov_b32 v31, v30
    s_nop 1
    v_permlane32_swap_b32 v30, v31
    v_max_f32 v30, v30, v31
    v_sub_f32 v31, 0, v30
    v_exp_f32 v31, v31
    v_add_f32 v28, v28, v30
    v_sub_f32 v30, 0, v30
    v_mul_f32 v29, v29, v31
    v_add_f32 v128, v128, v30
    v_add_f32 v129, v129, v30
    v_add_f32 v130, v130, v30
    v_add_f32 v131, v131, v30
    v_add_f32 v132, v132, v30
    v_add_f32 v133, v133, v30
    v_add_f32 v134, v134, v30
    v_add_f32 v135, v135, v30
    v_add_f32 v136, v136, v30
    v_add_f32 v137, v137, v30
    v_add_f32 v138, v138, v30
    v_add_f32 v139, v139, v30
    v_add_f32 v140, v140, v30
    v_add_f32 v141, v141, v30
    v_add_f32 v142, v142, v30
    v_add_f32 v143, v143, v30
    v_add_f32 v144, v144, v30
    v_add_f32 v145, v145, v30
    v_add_f32 v146, v146, v30
    v_add_f32 v147, v147, v30
    v_add_f32 v148, v148, v30
    v_add_f32 v149, v149, v30
    v_add_f32 v150, v150, v30
    v_add_f32 v151, v151, v30
    v_add_f32 v152, v152, v30
    v_add_f32 v153, v153, v30
    v_add_f32 v154, v154, v30
    v_add_f32 v155, v155, v30
    v_add_f32 v156, v156, v30
    v_add_f32 v157, v157, v30
    v_add_f32 v158, v158, v30
    v_add_f32 v159, v159, v30
    v_sub_f32 v232, 0, v28
    v_sub_f32 v233, 0, v28
    v_sub_f32 v234, 0, v28
    v_sub_f32 v235, 0, v28
    v_sub_f32 v236, 0, v28
    v_sub_f32 v237, 0, v28
    v_sub_f32 v238, 0, v28
    v_sub_f32 v239, 0, v28
    v_sub_f32 v240, 0, v28
    v_sub_f32 v241, 0, v28
    v_sub_f32 v242, 0, v28
    v_sub_f32 v243, 0, v28
    v_sub_f32 v244, 0, v28
    v_sub_f32 v245, 0, v28
    v_sub_f32 v246, 0, v28
    v_sub_f32 v247, 0, v28
attn_kernel_nr1:
    v_exp_f32 v128, v128
    v_exp_f32 v129, v129
    v_exp_f32 v130, v130
    v_exp_f32 v131, v131
    v_add_f32 v29, v29, v128
    v_add_f32 v29, v29, v129
    v_cvt_pk_bf16_f32 v176, v128, v129
    v_exp_f32 v132, v132
    v_exp_f32 v133, v133
    v_add_f32 v29, v29, v130
    v_add_f32 v29, v29, v131
    v_cvt_pk_bf16_f32 v177, v130, v131
    v_exp_f32 v134, v134
    v_exp_f32 v135, v135
    v_add_f32 v29, v29, v132
    v_add_f32 v29, v29, v133
    v_cvt_pk_bf16_f32 v178, v132, v133
    v_exp_f32 v136, v136
    v_exp_f32 v137, v137
    v_add_f32 v29, v29, v134
    v_add_f32 v29, v29, v135
    v_cvt_pk_bf16_f32 v179, v134, v135
    v_exp_f32 v138, v138
    v_exp_f32 v139, v139
    v_add_f32 v29, v29, v136
    v_add_f32 v29, v29, v137
    v_cvt_pk_bf16_f32 v180, v136, v137
    v_exp_f32 v140, v140
    v_exp_f32 v141, v141
    v_add_f32 v29, v29, v138
    v_add_f32 v29, v29, v139
    v_cvt_pk_bf16_f32 v181, v138, v139
    v_exp_f32 v142, v142
    v_exp_f32 v143, v143
    v_add_f32 v29, v29, v140
    v_add_f32 v29, v29, v141
    v_cvt_pk_bf16_f32 v182, v140, v141
    v_exp_f32 v144, v144
    v_exp_f32 v145, v145
    v_add_f32 v29, v29, v142
    v_add_f32 v29, v29, v143
    v_cvt_pk_bf16_f32 v183, v142, v143
    v_exp_f32 v146, v146
    v_exp_f32 v147, v147
    v_add_f32 v29, v29, v144
    v_add_f32 v29, v29, v145
    v_cvt_pk_bf16_f32 v184, v144, v145
    v_exp_f32 v148, v148
    v_exp_f32 v149, v149
    v_add_f32 v29, v29, v146
    v_add_f32 v29, v29, v147
    v_cvt_pk_bf16_f32 v185, v146, v147
    v_exp_f32 v150, v150
    v_exp_f32 v151, v151
    v_add_f32 v29, v29, v148
    v_add_f32 v29, v29, v149
    v_cvt_pk_bf16_f32 v186, v148, v149
    v_exp_f32 v152, v152
    v_exp_f32 v153, v153
    v_add_f32 v29, v29, v150
    v_add_f32 v29, v29, v151
    v_cvt_pk_bf16_f32 v187, v150, v151
    v_exp_f32 v154, v154
    v_exp_f32 v155, v155
    v_add_f32 v29, v29, v152
    v_add_f32 v29, v29, v153
    v_cvt_pk_bf16_f32 v188, v152, v153
    v_exp_f32 v156, v156
    v_exp_f32 v157, v157
    v_add_f32 v29, v29, v154
    v_add_f32 v29, v29, v155
    v_cvt_pk_bf16_f32 v189, v154, v155
    v_exp_f32 v158, v158
    v_exp_f32 v159, v159
    v_add_f32 v29, v29, v156
    v_add_f32 v29, v29, v157
    v_cvt_pk_bf16_f32 v190, v156, v157
    v_add_f32 v29, v29, v158
    v_add_f32 v29, v29, v159
    v_cvt_pk_bf16_f32 v191, v158, v159
    s_barrier
    s_setprio 1
    ds_read_b64_tr_b16 v[192:193], v24 offset:32768
    ds_read_b64_tr_b16 v[194:195], v24 offset:34816
    ds_read_b64_tr_b16 v[196:197], v25 offset:32768
    ds_read_b64_tr_b16 v[198:199], v25 offset:34816
    ds_read_b64_tr_b16 v[200:201], v26 offset:32768
    ds_read_b64_tr_b16 v[202:203], v26 offset:34816
    ds_read_b64_tr_b16 v[204:205], v27 offset:32768
    ds_read_b64_tr_b16 v[206:207], v27 offset:34816
    ds_read_b64_tr_b16 v[208:209], v24 offset:36864
    ds_read_b64_tr_b16 v[210:211], v24 offset:38912
    ds_read_b64_tr_b16 v[212:213], v25 offset:36864
    ds_read_b64_tr_b16 v[214:215], v25 offset:38912
    ds_read_b64_tr_b16 v[216:217], v26 offset:36864
    ds_read_b64_tr_b16 v[218:219], v26 offset:38912
    ds_read_b64_tr_b16 v[220:221], v27 offset:36864
    ds_read_b64_tr_b16 v[222:223], v27 offset:38912
    ds_read_b64_tr_b16 v[224:225], v24 offset:40960
    ds_read_b64_tr_b16 v[226:227], v24 offset:43008
    s_waitcnt lgkmcnt(15)
    v_mfma_f32_32x32x16_bf16 v[64:79], v[192:195], v[176:179], v[64:79]
    ds_read_b64_tr_b16 v[228:229], v25 offset:40960
    ds_read_b64_tr_b16 v[230:231], v25 offset:43008
    s_waitcnt lgkmcnt(15)
    v_mfma_f32_32x32x16_bf16 v[80:95], v[196:199], v[176:179], v[80:95]
    ds_read_b64_tr_b16 v[192:193], v26 offset:40960
    ds_read_b64_tr_b16 v[194:195], v26 offset:43008
    s_waitcnt lgkmcnt(15)
    v_mfma_f32_32x32x16_bf16 v[96:111], v[200:203], v[176:179], v[96:111]
    ds_read_b64_tr_b16 v[196:197], v27 offset:40960
    ds_read_b64_tr_b16 v[198:199], v27 offset:43008
    s_waitcnt lgkmcnt(15)
    v_mfma_f32_32x32x16_bf16 v[112:127], v[204:207], v[176:179], v[112:127]
    ds_read_b64_tr_b16 v[200:201], v24 offset:45056
    ds_read_b64_tr_b16 v[202:203], v24 offset:47104
    s_waitcnt lgkmcnt(15)
    v_mfma_f32_32x32x16_bf16 v[64:79], v[208:211], v[180:183], v[64:79]
    ds_read_b64_tr_b16 v[204:205], v25 offset:45056
    ds_read_b64_tr_b16 v[206:207], v25 offset:47104
    s_waitcnt lgkmcnt(15)
    v_mfma_f32_32x32x16_bf16 v[80:95], v[212:215], v[180:183], v[80:95]
    ds_read_b64_tr_b16 v[208:209], v26 offset:45056
    ds_read_b64_tr_b16 v[210:211], v26 offset:47104
    s_waitcnt lgkmcnt(15)
    v_mfma_f32_32x32x16_bf16 v[96:111], v[216:219], v[180:183], v[96:111]
    ds_read_b64_tr_b16 v[212:213], v27 offset:45056
    ds_read_b64_tr_b16 v[214:215], v27 offset:47104
    s_waitcnt lgkmcnt(15)
    v_mfma_f32_32x32x16_bf16 v[112:127], v[220:223], v[180:183], v[112:127]
    ds_read_b128 v[216:219], v16 offset:32768
    s_waitcnt lgkmcnt(15)
    v_mfma_f32_32x32x16_bf16 v[64:79], v[224:227], v[184:187], v[64:79]
    ds_read_b128 v[220:223], v17 offset:32768
    s_waitcnt lgkmcnt(14)
    v_mfma_f32_32x32x16_bf16 v[80:95], v[228:231], v[184:187], v[80:95]
    ds_read_b128 v[224:227], v18 offset:32768
    s_waitcnt lgkmcnt(13)
    v_mfma_f32_32x32x16_bf16 v[96:111], v[192:195], v[184:187], v[96:111]
    ds_read_b128 v[228:231], v19 offset:32768
    s_waitcnt lgkmcnt(12)
    v_mfma_f32_32x32x16_bf16 v[112:127], v[196:199], v[184:187], v[112:127]
    ds_read_b128 v[192:195], v20 offset:32768
    s_waitcnt lgkmcnt(11)
    v_mfma_f32_32x32x16_bf16 v[64:79], v[200:203], v[188:191], v[64:79]
    ds_read_b128 v[196:199], v21 offset:32768
    s_waitcnt lgkmcnt(10)
    v_mfma_f32_32x32x16_bf16 v[80:95], v[204:207], v[188:191], v[80:95]
    ds_read_b128 v[200:203], v22 offset:32768
    s_waitcnt lgkmcnt(9)
    v_mfma_f32_32x32x16_bf16 v[96:111], v[208:211], v[188:191], v[96:111]
    ds_read_b128 v[204:207], v23 offset:32768
    s_waitcnt lgkmcnt(8)
    v_mfma_f32_32x32x16_bf16 v[112:127], v[212:215], v[188:191], v[112:127]
    ds_read_b128 v[208:211], v16 offset:40960
    s_waitcnt lgkmcnt(8)
    v_mfma_f32_32x32x16_bf16 v[128:143], v[216:219], v[32:35], v[232:247]
    ds_read_b128 v[212:215], v17 offset:40960
    s_waitcnt lgkmcnt(8)
    v_mfma_f32_32x32x16_bf16 v[128:143], v[220:223], v[36:39], v[128:143]
    ds_read_b128 v[216:219], v18 offset:40960
    s_waitcnt lgkmcnt(8)
    v_mfma_f32_32x32x16_bf16 v[128:143], v[224:227], v[40:43], v[128:143]
    ds_read_b128 v[220:223], v19 offset:40960
    s_waitcnt lgkmcnt(8)
    v_mfma_f32_32x32x16_bf16 v[128:143], v[228:231], v[44:47], v[128:143]
    ds_read_b128 v[224:227], v20 offset:40960
    s_waitcnt lgkmcnt(8)
    v_mfma_f32_32x32x16_bf16 v[128:143], v[192:195], v[48:51], v[128:143]
    ds_read_b128 v[228:231], v21 offset:40960
    s_waitcnt lgkmcnt(8)
    v_mfma_f32_32x32x16_bf16 v[128:143], v[196:199], v[52:55], v[128:143]
    ds_read_b128 v[192:195], v22 offset:40960
    s_waitcnt lgkmcnt(8)
    v_mfma_f32_32x32x16_bf16 v[128:143], v[200:203], v[56:59], v[128:143]
    ds_read_b128 v[196:199], v23 offset:40960
    s_waitcnt lgkmcnt(8)
    v_mfma_f32_32x32x16_bf16 v[128:143], v[204:207], v[60:63], v[128:143]
    s_waitcnt lgkmcnt(7)
    v_mfma_f32_32x32x16_bf16 v[144:159], v[208:211], v[32:35], v[232:247]
    s_waitcnt lgkmcnt(6)
    v_mfma_f32_32x32x16_bf16 v[144:159], v[212:215], v[36:39], v[144:159]
    s_waitcnt lgkmcnt(5)
    v_mfma_f32_32x32x16_bf16 v[144:159], v[216:219], v[40:43], v[144:159]
    s_waitcnt lgkmcnt(4)
    v_mfma_f32_32x32x16_bf16 v[144:159], v[220:223], v[44:47], v[144:159]
    s_waitcnt lgkmcnt(3)
    v_mfma_f32_32x32x16_bf16 v[144:159], v[224:227], v[48:51], v[144:159]
    s_waitcnt lgkmcnt(2)
    v_mfma_f32_32x32x16_bf16 v[144:159], v[228:231], v[52:55], v[144:159]
    s_waitcnt lgkmcnt(1)
    v_mfma_f32_32x32x16_bf16 v[144:159], v[192:195], v[56:59], v[144:159]
    s_waitcnt lgkmcnt(0)
    v_mfma_f32_32x32x16_bf16 v[144:159], v[196:199], v[60:63], v[144:159]
    s_setprio 0
    s_waitcnt vmcnt(0)
    ds_write_b128 v11, v[160:163] offset:0
    ds_write_b128 v11, v[164:167] offset:8192
    ds_write_b128 v12, v[168:171] offset:0
    ds_write_b128 v12, v[172:175] offset:8192
    s_waitcnt lgkmcnt(0)
    s_barrier
    s_add_u32 s47, s47, 16384
    s_add_u32 s48, s48, 16384
    buffer_load_dwordx4 v[160:163], v10, s[12:15], s47 offen
    buffer_load_dwordx4 v[164:167], v6, s[12:15], s47 offen
    buffer_load_dwordx4 v[168:171], v10, s[16:19], s48 offen
    buffer_load_dwordx4 v[172:175], v6, s[16:19], s48 offen
    s_nop 7
    v_max3_f32 v30, v128, v129, v130
    v_max3_f32 v31, v131, v132, v133
    v_max3_f32 v30, v30, v134, v135
    v_max3_f32 v31, v31, v136, v137
    v_max3_f32 v30, v30, v138, v139
    v_max3_f32 v31, v31, v140, v141
    v_max3_f32 v30, v30, v142, v143
    v_max3_f32 v31, v31, v144, v145
    v_max3_f32 v30, v30, v146, v147
    v_max3_f32 v31, v31, v148, v149
    v_max3_f32 v30, v30, v150, v151
    v_max3_f32 v31, v31, v152, v153
    v_max3_f32 v30, v30, v154, v155
    v_max3_f32 v31, v31, v156, v157
    v_max3_f32 v30, v30, v158, v159
    v_max_f32 v30, v30, v31
    v_mov_b32 v31, v30
    s_nop 1
    v_permlane32_swap_b32 v30, v31
    v_max_f32 v30, v30, v31
    v_cmp_lt_f32 vcc, 0, v30
    s_cbranch_vccz attn_kernel_nr2
    v_max_f32 v30, 0, v30
    v_sub_f32 v31, 0, v30
    v_exp_f32 v31, v31
    v_add_f32 v28, v28, v30
    v_sub_f32 v30, 0, v30
    v_mul_f32 v29, v29, v31
    v_add_f32 v128, v128, v30
    v_add_f32 v129, v129, v30
    v_add_f32 v130, v130, v30
    v_add_f32 v131, v131, v30
    v_add_f32 v132, v132, v30
    v_add_f32 v133, v133, v30
    v_add_f32 v134, v134, v30
    v_add_f32 v135, v135, v30
    v_add_f32 v136, v136, v30
    v_add_f32 v137, v137, v30
    v_add_f32 v138, v138, v30
    v_add_f32 v139, v139, v30
    v_add_f32 v140, v140, v30
    v_add_f32 v141, v141, v30
    v_add_f32 v142, v142, v30
    v_add_f32 v143, v143, v30
    v_add_f32 v144, v144, v30
    v_add_f32 v145, v145, v30
    v_add_f32 v146, v146, v30
    v_add_f32 v147, v147, v30
    v_add_f32 v148, v148, v30
    v_add_f32 v149, v149, v30
    v_add_f32 v150, v150, v30
    v_add_f32 v151, v151, v30
    v_add_f32 v152, v152, v30
    v_add_f32 v153, v153, v30
    v_add_f32 v154, v154, v30
    v_add_f32 v155, v155, v30
    v_add_f32 v156, v156, v30
    v_add_f32 v157, v157, v30
    v_add_f32 v158, v158, v30
    v_add_f32 v159, v159, v30
    v_mul_f32 v64, v64, v31
    v_mul_f32 v65, v65, v31
    v_mul_f32 v66, v66, v31
    v_mul_f32 v67, v67, v31
    v_mul_f32 v68, v68, v31
    v_mul_f32 v69, v69, v31
    v_mul_f32 v70, v70, v31
    v_mul_f32 v71, v71, v31
    v_mul_f32 v72, v72, v31
    v_mul_f32 v73, v73, v31
    v_mul_f32 v74, v74, v31
    v_mul_f32 v75, v75, v31
    v_mul_f32 v76, v76, v31
    v_mul_f32 v77, v77, v31
    v_mul_f32 v78, v78, v31
    v_mul_f32 v79, v79, v31
    v_mul_f32 v80, v80, v31
    v_mul_f32 v81, v81, v31
    v_mul_f32 v82, v82, v31
    v_mul_f32 v83, v83, v31
    v_mul_f32 v84, v84, v31
    v_mul_f32 v85, v85, v31
    v_mul_f32 v86, v86, v31
    v_mul_f32 v87, v87, v31
    v_mul_f32 v88, v88, v31
    v_mul_f32 v89, v89, v31
    v_mul_f32 v90, v90, v31
    v_mul_f32 v91, v91, v31
    v_mul_f32 v92, v92, v31
    v_mul_f32 v93, v93, v31
    v_mul_f32 v94, v94, v31
    v_mul_f32 v95, v95, v31
    v_mul_f32 v96, v96, v31
    v_mul_f32 v97, v97, v31
    v_mul_f32 v98, v98, v31
    v_mul_f32 v99, v99, v31
    v_mul_f32 v100, v100, v31
    v_mul_f32 v101, v101, v31
    v_mul_f32 v102, v102, v31
    v_mul_f32 v103, v103, v31
    v_mul_f32 v104, v104, v31
    v_mul_f32 v105, v105, v31
    v_mul_f32 v106, v106, v31
    v_mul_f32 v107, v107, v31
    v_mul_f32 v108, v108, v31
    v_mul_f32 v109, v109, v31
    v_mul_f32 v110, v110, v31
    v_mul_f32 v111, v111, v31
    v_mul_f32 v112, v112, v31
    v_mul_f32 v113, v113, v31
    v_mul_f32 v114, v114, v31
    v_mul_f32 v115, v115, v31
    v_mul_f32 v116, v116, v31
    v_mul_f32 v117, v117, v31
    v_mul_f32 v118, v118, v31
    v_mul_f32 v119, v119, v31
    v_mul_f32 v120, v120, v31
    v_mul_f32 v121, v121, v31
    v_mul_f32 v122, v122, v31
    v_mul_f32 v123, v123, v31
    v_mul_f32 v124, v124, v31
    v_mul_f32 v125, v125, v31
    v_mul_f32 v126, v126, v31
    v_mul_f32 v127, v127, v31
    v_sub_f32 v232, 0, v28
    v_sub_f32 v233, 0, v28
    v_sub_f32 v234, 0, v28
    v_sub_f32 v235, 0, v28
    v_sub_f32 v236, 0, v28
    v_sub_f32 v237, 0, v28
    v_sub_f32 v238, 0, v28
    v_sub_f32 v239, 0, v28
    v_sub_f32 v240, 0, v28
    v_sub_f32 v241, 0, v28
    v_sub_f32 v242, 0, v28
    v_sub_f32 v243, 0, v28
    v_sub_f32 v244, 0, v28
    v_sub_f32 v245, 0, v28
    v_sub_f32 v246, 0, v28
    v_sub_f32 v247, 0, v28
attn_kernel_nr2:
    v_exp_f32 v128, v128
    v_exp_f32 v129, v129
    v_exp_f32 v130, v130
    v_exp_f32 v131, v131
    v_add_f32 v29, v29, v128
    v_add_f32 v29, v29, v129
    v_cvt_pk_bf16_f32 v176, v128, v129
    v_exp_f32 v132, v132
    v_exp_f32 v133, v133
    v_add_f32 v29, v29, v130
    v_add_f32 v29, v29, v131
    v_cvt_pk_bf16_f32 v177, v130, v131
    v_exp_f32 v134, v134
    v_exp_f32 v135, v135
    v_add_f32 v29, v29, v132
    v_add_f32 v29, v29, v133
    v_cvt_pk_bf16_f32 v178, v132, v133
    v_exp_f32 v136, v136
    v_exp_f32 v137, v137
    v_add_f32 v29, v29, v134
    v_add_f32 v29, v29, v135
    v_cvt_pk_bf16_f32 v179, v134, v135
    v_exp_f32 v138, v138
    v_exp_f32 v139, v139
    v_add_f32 v29, v29, v136
    v_add_f32 v29, v29, v137
    v_cvt_pk_bf16_f32 v180, v136, v137
    v_exp_f32 v140, v140
    v_exp_f32 v141, v141
    v_add_f32 v29, v29, v138
    v_add_f32 v29, v29, v139
    v_cvt_pk_bf16_f32 v181, v138, v139
    v_exp_f32 v142, v142
    v_exp_f32 v143, v143
    v_add_f32 v29, v29, v140
    v_add_f32 v29, v29, v141
    v_cvt_pk_bf16_f32 v182, v140, v141
    v_exp_f32 v144, v144
    v_exp_f32 v145, v145
    v_add_f32 v29, v29, v142
    v_add_f32 v29, v29, v143
    v_cvt_pk_bf16_f32 v183, v142, v143
    v_exp_f32 v146, v146
    v_exp_f32 v147, v147
    v_add_f32 v29, v29, v144
    v_add_f32 v29, v29, v145
    v_cvt_pk_bf16_f32 v184, v144, v145
    v_exp_f32 v148, v148
    v_exp_f32 v149, v149
    v_add_f32 v29, v29, v146
    v_add_f32 v29, v29, v147
    v_cvt_pk_bf16_f32 v185, v146, v147
    v_exp_f32 v150, v150
    v_exp_f32 v151, v151
    v_add_f32 v29, v29, v148
    v_add_f32 v29, v29, v149
    v_cvt_pk_bf16_f32 v186, v148, v149
    v_exp_f32 v152, v152
    v_exp_f32 v153, v153
    v_add_f32 v29, v29, v150
    v_add_f32 v29, v29, v151
    v_cvt_pk_bf16_f32 v187, v150, v151
    v_exp_f32 v154, v154
    v_exp_f32 v155, v155
    v_add_f32 v29, v29, v152
    v_add_f32 v29, v29, v153
    v_cvt_pk_bf16_f32 v188, v152, v153
    v_exp_f32 v156, v156
    v_exp_f32 v157, v157
    v_add_f32 v29, v29, v154
    v_add_f32 v29, v29, v155
    v_cvt_pk_bf16_f32 v189, v154, v155
    v_exp_f32 v158, v158
    v_exp_f32 v159, v159
    v_add_f32 v29, v29, v156
    v_add_f32 v29, v29, v157
    v_cvt_pk_bf16_f32 v190, v156, v157
    v_add_f32 v29, v29, v158
    v_add_f32 v29, v29, v159
    v_cvt_pk_bf16_f32 v191, v158, v159
    s_barrier
    s_mov_b32 s49, 2
attn_kernel_loop:
    s_setprio 1
    ds_read_b64_tr_b16 v[192:193], v24 offset:0
    ds_read_b64_tr_b16 v[194:195], v24 offset:2048
    ds_read_b64_tr_b16 v[196:197], v25 offset:0
    ds_read_b64_tr_b16 v[198:199], v25 offset:2048
    ds_read_b64_tr_b16 v[200:201], v26 offset:0
    ds_read_b64_tr_b16 v[202:203], v26 offset:2048
    ds_read_b64_tr_b16 v[204:205], v27 offset:0
    ds_read_b64_tr_b16 v[206:207], v27 offset:2048
    ds_read_b64_tr_b16 v[208:209], v24 offset:4096
    ds_read_b64_tr_b16 v[210:211], v24 offset:6144
    ds_read_b64_tr_b16 v[212:213], v25 offset:4096
    ds_read_b64_tr_b16 v[214:215], v25 offset:6144
    ds_read_b64_tr_b16 v[216:217], v26 offset:4096
    ds_read_b64_tr_b16 v[218:219], v26 offset:6144
    ds_read_b64_tr_b16 v[220:221], v27 offset:4096
    ds_read_b64_tr_b16 v[222:223], v27 offset:6144
    ds_read_b64_tr_b16 v[224:225], v24 offset:8192
    ds_read_b64_tr_b16 v[226:227], v24 offset:10240
    s_waitcnt lgkmcnt(15)
    v_mfma_f32_32x32x16_bf16 v[64:79], v[192:195], v[176:179], v[64:79]
    ds_read_b64_tr_b16 v[228:229], v25 offset:8192
    ds_read_b64_tr_b16 v[230:231], v25 offset:10240
    s_waitcnt lgkmcnt(15)
    v_mfma_f32_32x32x16_bf16 v[80:95], v[196:199], v[176:179], v[80:95]
    ds_read_b64_tr_b16 v[192:193], v26 offset:8192
    ds_read_b64_tr_b16 v[194:195], v26 offset:10240
    s_waitcnt lgkmcnt(15)
    v_mfma_f32_32x32x16_bf16 v[96:111], v[200:203], v[176:179], v[96:111]
    ds_read_b64_tr_b16 v[196:197], v27 offset:8192
    ds_read_b64_tr_b16 v[198:199], v27 offset:10240
    s_waitcnt lgkmcnt(15)
    v_mfma_f32_32x32x16_bf16 v[112:127], v[204:207], v[176:179], v[112:127]
    ds_read_b64_tr_b16 v[200:201], v24 offset:12288
    ds_read_b64_tr_b16 v[202:203], v24 offset:14336
    s_waitcnt lgkmcnt(15)
    v_mfma_f32_32x32x16_bf16 v[64:79], v[208:211], v[180:183], v[64:79]
    ds_read_b64_tr_b16 v[204:205], v25 offset:12288
    ds_read_b64_tr_b16 v[206:207], v25 offset:14336
    s_waitcnt lgkmcnt(15)
    v_mfma_f32_32x32x16_bf16 v[80:95], v[212:215], v[180:183], v[80:95]
    ds_read_b64_tr_b16 v[208:209], v26 offset:12288
    ds_read_b64_tr_b16 v[210:211], v26 offset:14336
    s_waitcnt lgkmcnt(15)
    v_mfma_f32_32x32x16_bf16 v[96:111], v[216:219], v[180:183], v[96:111]
    ds_read_b64_tr_b16 v[212:213], v27 offset:12288
    ds_read_b64_tr_b16 v[214:215], v27 offset:14336
    s_waitcnt lgkmcnt(15)
    v_mfma_f32_32x32x16_bf16 v[112:127], v[220:223], v[180:183], v[112:127]
    ds_read_b128 v[216:219], v16 offset:0
    s_waitcnt lgkmcnt(15)
    v_mfma_f32_32x32x16_bf16 v[64:79], v[224:227], v[184:187], v[64:79]
    ds_read_b128 v[220:223], v17 offset:0
    s_waitcnt lgkmcnt(14)
    v_mfma_f32_32x32x16_bf16 v[80:95], v[228:231], v[184:187], v[80:95]
    ds_read_b128 v[224:227], v18 offset:0
    s_waitcnt lgkmcnt(13)
    v_mfma_f32_32x32x16_bf16 v[96:111], v[192:195], v[184:187], v[96:111]
    ds_read_b128 v[228:231], v19 offset:0
    s_waitcnt lgkmcnt(12)
    v_mfma_f32_32x32x16_bf16 v[112:127], v[196:199], v[184:187], v[112:127]
    ds_read_b128 v[192:195], v20 offset:0
    s_waitcnt lgkmcnt(11)
    v_mfma_f32_32x32x16_bf16 v[64:79], v[200:203], v[188:191], v[64:79]
    ds_read_b128 v[196:199], v21 offset:0
    s_waitcnt lgkmcnt(10)
    v_mfma_f32_32x32x16_bf16 v[80:95], v[204:207], v[188:191], v[80:95]
    ds_read_b128 v[200:203], v22 offset:0
    s_waitcnt lgkmcnt(9)
    v_mfma_f32_32x32x16_bf16 v[96:111], v[208:211], v[188:191], v[96:111]
    ds_read_b128 v[204:207], v23 offset:0
    s_waitcnt lgkmcnt(8)
    v_mfma_f32_32x32x16_bf16 v[112:127], v[212:215], v[188:191], v[112:127]
    ds_read_b128 v[208:211], v16 offset:8192
    s_waitcnt lgkmcnt(8)
    v_mfma_f32_32x32x16_bf16 v[128:143], v[216:219], v[32:35], v[232:247]
    ds_read_b128 v[212:215], v17 offset:8192
    s_waitcnt lgkmcnt(8)
    v_mfma_f32_32x32x16_bf16 v[128:143], v[220:223], v[36:39], v[128:143]
    ds_read_b128 v[216:219], v18 offset:8192
    s_waitcnt lgkmcnt(8)
    v_mfma_f32_32x32x16_bf16 v[128:143], v[224:227], v[40:43], v[128:143]
    ds_read_b128 v[220:223], v19 offset:8192
    s_waitcnt lgkmcnt(8)
    v_mfma_f32_32x32x16_bf16 v[128:143], v[228:231], v[44:47], v[128:143]
    ds_read_b128 v[224:227], v20 offset:8192
    s_waitcnt lgkmcnt(8)
    v_mfma_f32_32x32x16_bf16 v[128:143], v[192:195], v[48:51], v[128:143]
    ds_read_b128 v[228:231], v21 offset:8192
    s_waitcnt lgkmcnt(8)
    v_mfma_f32_32x32x16_bf16 v[128:143], v[196:199], v[52:55], v[128:143]
    ds_read_b128 v[192:195], v22 offset:8192
    s_waitcnt lgkmcnt(8)
    v_mfma_f32_32x32x16_bf16 v[128:143], v[200:203], v[56:59], v[128:143]
    ds_read_b128 v[196:199], v23 offset:8192
    s_waitcnt lgkmcnt(8)
    v_mfma_f32_32x32x16_bf16 v[128:143], v[204:207], v[60:63], v[128:143]
    s_waitcnt lgkmcnt(7)
    v_mfma_f32_32x32x16_bf16 v[144:159], v[208:211], v[32:35], v[232:247]
    s_waitcnt lgkmcnt(6)
    v_mfma_f32_32x32x16_bf16 v[144:159], v[212:215], v[36:39], v[144:159]
    s_waitcnt lgkmcnt(5)
    v_mfma_f32_32x32x16_bf16 v[144:159], v[216:219], v[40:43], v[144:159]
    s_waitcnt lgkmcnt(4)
    v_mfma_f32_32x32x16_bf16 v[144:159], v[220:223], v[44:47], v[144:159]
    s_waitcnt lgkmcnt(3)
    v_mfma_f32_32x32x16_bf16 v[144:159], v[224:227], v[48:51], v[144:159]
    s_waitcnt lgkmcnt(2)
    v_mfma_f32_32x32x16_bf16 v[144:159], v[228:231], v[52:55], v[144:159]
    s_waitcnt lgkmcnt(1)
    v_mfma_f32_32x32x16_bf16 v[144:159], v[192:195], v[56:59], v[144:159]
    s_waitcnt lgkmcnt(0)
    v_mfma_f32_32x32x16_bf16 v[144:159], v[196:199], v[60:63], v[144:159]
    s_setprio 0
    s_waitcnt vmcnt(0)
    ds_write_b128 v11, v[160:163] offset:32768
    ds_write_b128 v11, v[164:167] offset:40960
    ds_write_b128 v12, v[168:171] offset:32768
    ds_write_b128 v12, v[172:175] offset:40960
    s_waitcnt lgkmcnt(0)
    s_barrier
    s_add_u32 s47, s47, 16384
    s_add_u32 s48, s48, 16384
    buffer_load_dwordx4 v[160:163], v10, s[12:15], s47 offen
    buffer_load_dwordx4 v[164:167], v6, s[12:15], s47 offen
    buffer_load_dwordx4 v[168:171], v10, s[16:19], s48 offen
    buffer_load_dwordx4 v[172:175], v6, s[16:19], s48 offen
    s_nop 7
    v_max3_f32 v30, v128, v129, v130
    v_max3_f32 v31, v131, v132, v133
    v_max3_f32 v30, v30, v134, v135
    v_max3_f32 v31, v31, v136, v137
    v_max3_f32 v30, v30, v138, v139
    v_max3_f32 v31, v31, v140, v141
    v_max3_f32 v30, v30, v142, v143
    v_max3_f32 v31, v31, v144, v145
    v_max3_f32 v30, v30, v146, v147
    v_max3_f32 v31, v31, v148, v149
    v_max3_f32 v30, v30, v150, v151
    v_max3_f32 v31, v31, v152, v153
    v_max3_f32 v30, v30, v154, v155
    v_max3_f32 v31, v31, v156, v157
    v_max3_f32 v30, v30, v158, v159
    v_max_f32 v30, v30, v31
    v_mov_b32 v31, v30
    s_nop 1
    v_permlane32_swap_b32 v30, v31
    v_max_f32 v30, v30, v31
    v_cmp_lt_f32 vcc, 0, v30
    s_cbranch_vccz attn_kernel_nr3
    v_max_f32 v30, 0, v30
    v_sub_f32 v31, 0, v30
    v_exp_f32 v31, v31
    v_add_f32 v28, v28, v30
    v_sub_f32 v30, 0, v30
    v_mul_f32 v29, v29, v31
    v_add_f32 v128, v128, v30
    v_add_f32 v129, v129, v30
    v_add_f32 v130, v130, v30
    v_add_f32 v131, v131, v30
    v_add_f32 v132, v132, v30
    v_add_f32 v133, v133, v30
    v_add_f32 v134, v134, v30
    v_add_f32 v135, v135, v30
    v_add_f32 v136, v136, v30
    v_add_f32 v137, v137, v30
    v_add_f32 v138, v138, v30
    v_add_f32 v139, v139, v30
    v_add_f32 v140, v140, v30
    v_add_f32 v141, v141, v30
    v_add_f32 v142, v142, v30
    v_add_f32 v143, v143, v30
    v_add_f32 v144, v144, v30
    v_add_f32 v145, v145, v30
    v_add_f32 v146, v146, v30
    v_add_f32 v147, v147, v30
    v_add_f32 v148, v148, v30
    v_add_f32 v149, v149, v30
    v_add_f32 v150, v150, v30
    v_add_f32 v151, v151, v30
    v_add_f32 v152, v152, v30
    v_add_f32 v153, v153, v30
    v_add_f32 v154, v154, v30
    v_add_f32 v155, v155, v30
    v_add_f32 v156, v156, v30
    v_add_f32 v157, v157, v30
    v_add_f32 v158, v158, v30
    v_add_f32 v159, v159, v30
    v_mul_f32 v64, v64, v31
    v_mul_f32 v65, v65, v31
    v_mul_f32 v66, v66, v31
    v_mul_f32 v67, v67, v31
    v_mul_f32 v68, v68, v31
    v_mul_f32 v69, v69, v31
    v_mul_f32 v70, v70, v31
    v_mul_f32 v71, v71, v31
    v_mul_f32 v72, v72, v31
    v_mul_f32 v73, v73, v31
    v_mul_f32 v74, v74, v31
    v_mul_f32 v75, v75, v31
    v_mul_f32 v76, v76, v31
    v_mul_f32 v77, v77, v31
    v_mul_f32 v78, v78, v31
    v_mul_f32 v79, v79, v31
    v_mul_f32 v80, v80, v31
    v_mul_f32 v81, v81, v31
    v_mul_f32 v82, v82, v31
    v_mul_f32 v83, v83, v31
    v_mul_f32 v84, v84, v31
    v_mul_f32 v85, v85, v31
    v_mul_f32 v86, v86, v31
    v_mul_f32 v87, v87, v31
    v_mul_f32 v88, v88, v31
    v_mul_f32 v89, v89, v31
    v_mul_f32 v90, v90, v31
    v_mul_f32 v91, v91, v31
    v_mul_f32 v92, v92, v31
    v_mul_f32 v93, v93, v31
    v_mul_f32 v94, v94, v31
    v_mul_f32 v95, v95, v31
    v_mul_f32 v96, v96, v31
    v_mul_f32 v97, v97, v31
    v_mul_f32 v98, v98, v31
    v_mul_f32 v99, v99, v31
    v_mul_f32 v100, v100, v31
    v_mul_f32 v101, v101, v31
    v_mul_f32 v102, v102, v31
    v_mul_f32 v103, v103, v31
    v_mul_f32 v104, v104, v31
    v_mul_f32 v105, v105, v31
    v_mul_f32 v106, v106, v31
    v_mul_f32 v107, v107, v31
    v_mul_f32 v108, v108, v31
    v_mul_f32 v109, v109, v31
    v_mul_f32 v110, v110, v31
    v_mul_f32 v111, v111, v31
    v_mul_f32 v112, v112, v31
    v_mul_f32 v113, v113, v31
    v_mul_f32 v114, v114, v31
    v_mul_f32 v115, v115, v31
    v_mul_f32 v116, v116, v31
    v_mul_f32 v117, v117, v31
    v_mul_f32 v118, v118, v31
    v_mul_f32 v119, v119, v31
    v_mul_f32 v120, v120, v31
    v_mul_f32 v121, v121, v31
    v_mul_f32 v122, v122, v31
    v_mul_f32 v123, v123, v31
    v_mul_f32 v124, v124, v31
    v_mul_f32 v125, v125, v31
    v_mul_f32 v126, v126, v31
    v_mul_f32 v127, v127, v31
    v_sub_f32 v232, 0, v28
    v_sub_f32 v233, 0, v28
    v_sub_f32 v234, 0, v28
    v_sub_f32 v235, 0, v28
    v_sub_f32 v236, 0, v28
    v_sub_f32 v237, 0, v28
    v_sub_f32 v238, 0, v28
    v_sub_f32 v239, 0, v28
    v_sub_f32 v240, 0, v28
    v_sub_f32 v241, 0, v28
    v_sub_f32 v242, 0, v28
    v_sub_f32 v243, 0, v28
    v_sub_f32 v244, 0, v28
    v_sub_f32 v245, 0, v28
    v_sub_f32 v246, 0, v28
    v_sub_f32 v247, 0, v28
attn_kernel_nr3:
    v_exp_f32 v128, v128
    v_exp_f32 v129, v129
    v_exp_f32 v130, v130
    v_exp_f32 v131, v131
    v_add_f32 v29, v29, v128
    v_add_f32 v29, v29, v129
    v_cvt_pk_bf16_f32 v176, v128, v129
    v_exp_f32 v132, v132
    v_exp_f32 v133, v133
    v_add_f32 v29, v29, v130
    v_add_f32 v29, v29, v131
    v_cvt_pk_bf16_f32 v177, v130, v131
    v_exp_f32 v134, v134
    v_exp_f32 v135, v135
    v_add_f32 v29, v29, v132
    v_add_f32 v29, v29, v133
    v_cvt_pk_bf16_f32 v178, v132, v133
    v_exp_f32 v136, v136
    v_exp_f32 v137, v137
    v_add_f32 v29, v29, v134
    v_add_f32 v29, v29, v135
    v_cvt_pk_bf16_f32 v179, v134, v135
    v_exp_f32 v138, v138
    v_exp_f32 v139, v139
    v_add_f32 v29, v29, v136
    v_add_f32 v29, v29, v137
    v_cvt_pk_bf16_f32 v180, v136, v137
    v_exp_f32 v140, v140
    v_exp_f32 v141, v141
    v_add_f32 v29, v29, v138
    v_add_f32 v29, v29, v139
    v_cvt_pk_bf16_f32 v181, v138, v139
    v_exp_f32 v142, v142
    v_exp_f32 v143, v143
    v_add_f32 v29, v29, v140
    v_add_f32 v29, v29, v141
    v_cvt_pk_bf16_f32 v182, v140, v141
    v_exp_f32 v144, v144
    v_exp_f32 v145, v145
    v_add_f32 v29, v29, v142
    v_add_f32 v29, v29, v143
    v_cvt_pk_bf16_f32 v183, v142, v143
    v_exp_f32 v146, v146
    v_exp_f32 v147, v147
    v_add_f32 v29, v29, v144
    v_add_f32 v29, v29, v145
    v_cvt_pk_bf16_f32 v184, v144, v145
    v_exp_f32 v148, v148
    v_exp_f32 v149, v149
    v_add_f32 v29, v29, v146
    v_add_f32 v29, v29, v147
    v_cvt_pk_bf16_f32 v185, v146, v147
    v_exp_f32 v150, v150
    v_exp_f32 v151, v151
    v_add_f32 v29, v29, v148
    v_add_f32 v29, v29, v149
    v_cvt_pk_bf16_f32 v186, v148, v149
    v_exp_f32 v152, v152
    v_exp_f32 v153, v153
    v_add_f32 v29, v29, v150
    v_add_f32 v29, v29, v151
    v_cvt_pk_bf16_f32 v187, v150, v151
    v_exp_f32 v154, v154
    v_exp_f32 v155, v155
    v_add_f32 v29, v29, v152
    v_add_f32 v29, v29, v153
    v_cvt_pk_bf16_f32 v188, v152, v153
    v_exp_f32 v156, v156
    v_exp_f32 v157, v157
    v_add_f32 v29, v29, v154
    v_add_f32 v29, v29, v155
    v_cvt_pk_bf16_f32 v189, v154, v155
    v_exp_f32 v158, v158
    v_exp_f32 v159, v159
    v_add_f32 v29, v29, v156
    v_add_f32 v29, v29, v157
    v_cvt_pk_bf16_f32 v190, v156, v157
    v_add_f32 v29, v29, v158
    v_add_f32 v29, v29, v159
    v_cvt_pk_bf16_f32 v191, v158, v159
    s_barrier
    s_setprio 1
    ds_read_b64_tr_b16 v[192:193], v24 offset:32768
    ds_read_b64_tr_b16 v[194:195], v24 offset:34816
    ds_read_b64_tr_b16 v[196:197], v25 offset:32768
    ds_read_b64_tr_b16 v[198:199], v25 offset:34816
    ds_read_b64_tr_b16 v[200:201], v26 offset:32768
    ds_read_b64_tr_b16 v[202:203], v26 offset:34816
    ds_read_b64_tr_b16 v[204:205], v27 offset:32768
    ds_read_b64_tr_b16 v[206:207], v27 offset:34816
    ds_read_b64_tr_b16 v[208:209], v24 offset:36864
    ds_read_b64_tr_b16 v[210:211], v24 offset:38912
    ds_read_b64_tr_b16 v[212:213], v25 offset:36864
    ds_read_b64_tr_b16 v[214:215], v25 offset:38912
    ds_read_b64_tr_b16 v[216:217], v26 offset:36864
    ds_read_b64_tr_b16 v[218:219], v26 offset:38912
    ds_read_b64_tr_b16 v[220:221], v27 offset:36864
    ds_read_b64_tr_b16 v[222:223], v27 offset:38912
    ds_read_b64_tr_b16 v[224:225], v24 offset:40960
    ds_read_b64_tr_b16 v[226:227], v24 offset:43008
    s_waitcnt lgkmcnt(15)
    v_mfma_f32_32x32x16_bf16 v[64:79], v[192:195], v[176:179], v[64:79]
    ds_read_b64_tr_b16 v[228:229], v25 offset:40960
    ds_read_b64_tr_b16 v[230:231], v25 offset:43008
    s_waitcnt lgkmcnt(15)
    v_mfma_f32_32x32x16_bf16 v[80:95], v[196:199], v[176:179], v[80:95]
    ds_read_b64_tr_b16 v[192:193], v26 offset:40960
    ds_read_b64_tr_b16 v[194:195], v26 offset:43008
    s_waitcnt lgkmcnt(15)
    v_mfma_f32_32x32x16_bf16 v[96:111], v[200:203], v[176:179], v[96:111]
    ds_read_b64_tr_b16 v[196:197], v27 offset:40960
    ds_read_b64_tr_b16 v[198:199], v27 offset:43008
    s_waitcnt lgkmcnt(15)
    v_mfma_f32_32x32x16_bf16 v[112:127], v[204:207], v[176:179], v[112:127]
    ds_read_b64_tr_b16 v[200:201], v24 offset:45056
    ds_read_b64_tr_b16 v[202:203], v24 offset:47104
    s_waitcnt lgkmcnt(15)
    v_mfma_f32_32x32x16_bf16 v[64:79], v[208:211], v[180:183], v[64:79]
    ds_read_b64_tr_b16 v[204:205], v25 offset:45056
    ds_read_b64_tr_b16 v[206:207], v25 offset:47104
    s_waitcnt lgkmcnt(15)
    v_mfma_f32_32x32x16_bf16 v[80:95], v[212:215], v[180:183], v[80:95]
    ds_read_b64_tr_b16 v[208:209], v26 offset:45056
    ds_read_b64_tr_b16 v[210:211], v26 offset:47104
    s_waitcnt lgkmcnt(15)
    v_mfma_f32_32x32x16_bf16 v[96:111], v[216:219], v[180:183], v[96:111]
    ds_read_b64_tr_b16 v[212:213], v27 offset:45056
    ds_read_b64_tr_b16 v[214:215], v27 offset:47104
    s_waitcnt lgkmcnt(15)
    v_mfma_f32_32x32x16_bf16 v[112:127], v[220:223], v[180:183], v[112:127]
    ds_read_b128 v[216:219], v16 offset:32768
    s_waitcnt lgkmcnt(15)
    v_mfma_f32_32x32x16_bf16 v[64:79], v[224:227], v[184:187], v[64:79]
    ds_read_b128 v[220:223], v17 offset:32768
    s_waitcnt lgkmcnt(14)
    v_mfma_f32_32x32x16_bf16 v[80:95], v[228:231], v[184:187], v[80:95]
    ds_read_b128 v[224:227], v18 offset:32768
    s_waitcnt lgkmcnt(13)
    v_mfma_f32_32x32x16_bf16 v[96:111], v[192:195], v[184:187], v[96:111]
    ds_read_b128 v[228:231], v19 offset:32768
    s_waitcnt lgkmcnt(12)
    v_mfma_f32_32x32x16_bf16 v[112:127], v[196:199], v[184:187], v[112:127]
    ds_read_b128 v[192:195], v20 offset:32768
    s_waitcnt lgkmcnt(11)
    v_mfma_f32_32x32x16_bf16 v[64:79], v[200:203], v[188:191], v[64:79]
    ds_read_b128 v[196:199], v21 offset:32768
    s_waitcnt lgkmcnt(10)
    v_mfma_f32_32x32x16_bf16 v[80:95], v[204:207], v[188:191], v[80:95]
    ds_read_b128 v[200:203], v22 offset:32768
    s_waitcnt lgkmcnt(9)
    v_mfma_f32_32x32x16_bf16 v[96:111], v[208:211], v[188:191], v[96:111]
    ds_read_b128 v[204:207], v23 offset:32768
    s_waitcnt lgkmcnt(8)
    v_mfma_f32_32x32x16_bf16 v[112:127], v[212:215], v[188:191], v[112:127]
    ds_read_b128 v[208:211], v16 offset:40960
    s_waitcnt lgkmcnt(8)
    v_mfma_f32_32x32x16_bf16 v[128:143], v[216:219], v[32:35], v[232:247]
    ds_read_b128 v[212:215], v17 offset:40960
    s_waitcnt lgkmcnt(8)
    v_mfma_f32_32x32x16_bf16 v[128:143], v[220:223], v[36:39], v[128:143]
    ds_read_b128 v[216:219], v18 offset:40960
    s_waitcnt lgkmcnt(8)
    v_mfma_f32_32x32x16_bf16 v[128:143], v[224:227], v[40:43], v[128:143]
    ds_read_b128 v[220:223], v19 offset:40960
    s_waitcnt lgkmcnt(8)
    v_mfma_f32_32x32x16_bf16 v[128:143], v[228:231], v[44:47], v[128:143]
    ds_read_b128 v[224:227], v20 offset:40960
    s_waitcnt lgkmcnt(8)
    v_mfma_f32_32x32x16_bf16 v[128:143], v[192:195], v[48:51], v[128:143]
    ds_read_b128 v[228:231], v21 offset:40960
    s_waitcnt lgkmcnt(8)
    v_mfma_f32_32x32x16_bf16 v[128:143], v[196:199], v[52:55], v[128:143]
    ds_read_b128 v[192:195], v22 offset:40960
    s_waitcnt lgkmcnt(8)
    v_mfma_f32_32x32x16_bf16 v[128:143], v[200:203], v[56:59], v[128:143]
    ds_read_b128 v[196:199], v23 offset:40960
    s_waitcnt lgkmcnt(8)
    v_mfma_f32_32x32x16_bf16 v[128:143], v[204:207], v[60:63], v[128:143]
    s_waitcnt lgkmcnt(7)
    v_mfma_f32_32x32x16_bf16 v[144:159], v[208:211], v[32:35], v[232:247]
    s_waitcnt lgkmcnt(6)
    v_mfma_f32_32x32x16_bf16 v[144:159], v[212:215], v[36:39], v[144:159]
    s_waitcnt lgkmcnt(5)
    v_mfma_f32_32x32x16_bf16 v[144:159], v[216:219], v[40:43], v[144:159]
    s_waitcnt lgkmcnt(4)
    v_mfma_f32_32x32x16_bf16 v[144:159], v[220:223], v[44:47], v[144:159]
    s_waitcnt lgkmcnt(3)
    v_mfma_f32_32x32x16_bf16 v[144:159], v[224:227], v[48:51], v[144:159]
    s_waitcnt lgkmcnt(2)
    v_mfma_f32_32x32x16_bf16 v[144:159], v[228:231], v[52:55], v[144:159]
    s_waitcnt lgkmcnt(1)
    v_mfma_f32_32x32x16_bf16 v[144:159], v[192:195], v[56:59], v[144:159]
    s_waitcnt lgkmcnt(0)
    v_mfma_f32_32x32x16_bf16 v[144:159], v[196:199], v[60:63], v[144:159]
    s_setprio 0
    s_waitcnt vmcnt(0)
    ds_write_b128 v11, v[160:163] offset:0
    ds_write_b128 v11, v[164:167] offset:8192
    ds_write_b128 v12, v[168:171] offset:0
    ds_write_b128 v12, v[172:175] offset:8192
    s_waitcnt lgkmcnt(0)
    s_barrier
    s_add_u32 s47, s47, 16384
    s_add_u32 s48, s48, 16384
    buffer_load_dwordx4 v[160:163], v10, s[12:15], s47 offen
    buffer_load_dwordx4 v[164:167], v6, s[12:15], s47 offen
    buffer_load_dwordx4 v[168:171], v10, s[16:19], s48 offen
    buffer_load_dwordx4 v[172:175], v6, s[16:19], s48 offen
    s_nop 7
    v_max3_f32 v30, v128, v129, v130
    v_max3_f32 v31, v131, v132, v133
    v_max3_f32 v30, v30, v134, v135
    v_max3_f32 v31, v31, v136, v137
    v_max3_f32 v30, v30, v138, v139
    v_max3_f32 v31, v31, v140, v141
    v_max3_f32 v30, v30, v142, v143
    v_max3_f32 v31, v31, v144, v145
    v_max3_f32 v30, v30, v146, v147
    v_max3_f32 v31, v31, v148, v149
    v_max3_f32 v30, v30, v150, v151
    v_max3_f32 v31, v31, v152, v153
    v_max3_f32 v30, v30, v154, v155
    v_max3_f32 v31, v31, v156, v157
    v_max3_f32 v30, v30, v158, v159
    v_max_f32 v30, v30, v31
    v_mov_b32 v31, v30
    s_nop 1
    v_permlane32_swap_b32 v30, v31
    v_max_f32 v30, v30, v31
    v_cmp_lt_f32 vcc, 0, v30
    s_cbranch_vccz attn_kernel_nr4
    v_max_f32 v30, 0, v30
    v_sub_f32 v31, 0, v30
    v_exp_f32 v31, v31
    v_add_f32 v28, v28, v30
    v_sub_f32 v30, 0, v30
    v_mul_f32 v29, v29, v31
    v_add_f32 v128, v128, v30
    v_add_f32 v129, v129, v30
    v_add_f32 v130, v130, v30
    v_add_f32 v131, v131, v30
    v_add_f32 v132, v132, v30
    v_add_f32 v133, v133, v30
    v_add_f32 v134, v134, v30
    v_add_f32 v135, v135, v30
    v_add_f32 v136, v136, v30
    v_add_f32 v137, v137, v30
    v_add_f32 v138, v138, v30
    v_add_f32 v139, v139, v30
    v_add_f32 v140, v140, v30
    v_add_f32 v141, v141, v30
    v_add_f32 v142, v142, v30
    v_add_f32 v143, v143, v30
    v_add_f32 v144, v144, v30
    v_add_f32 v145, v145, v30
    v_add_f32 v146, v146, v30
    v_add_f32 v147, v147, v30
    v_add_f32 v148, v148, v30
    v_add_f32 v149, v149, v30
    v_add_f32 v150, v150, v30
    v_add_f32 v151, v151, v30
    v_add_f32 v152, v152, v30
    v_add_f32 v153, v153, v30
    v_add_f32 v154, v154, v30
    v_add_f32 v155, v155, v30
    v_add_f32 v156, v156, v30
    v_add_f32 v157, v157, v30
    v_add_f32 v158, v158, v30
    v_add_f32 v159, v159, v30
    v_mul_f32 v64, v64, v31
    v_mul_f32 v65, v65, v31
    v_mul_f32 v66, v66, v31
    v_mul_f32 v67, v67, v31
    v_mul_f32 v68, v68, v31
    v_mul_f32 v69, v69, v31
    v_mul_f32 v70, v70, v31
    v_mul_f32 v71, v71, v31
    v_mul_f32 v72, v72, v31
    v_mul_f32 v73, v73, v31
    v_mul_f32 v74, v74, v31
    v_mul_f32 v75, v75, v31
    v_mul_f32 v76, v76, v31
    v_mul_f32 v77, v77, v31
    v_mul_f32 v78, v78, v31
    v_mul_f32 v79, v79, v31
    v_mul_f32 v80, v80, v31
    v_mul_f32 v81, v81, v31
    v_mul_f32 v82, v82, v31
    v_mul_f32 v83, v83, v31
    v_mul_f32 v84, v84, v31
    v_mul_f32 v85, v85, v31
    v_mul_f32 v86, v86, v31
    v_mul_f32 v87, v87, v31
    v_mul_f32 v88, v88, v31
    v_mul_f32 v89, v89, v31
    v_mul_f32 v90, v90, v31
    v_mul_f32 v91, v91, v31
    v_mul_f32 v92, v92, v31
    v_mul_f32 v93, v93, v31
    v_mul_f32 v94, v94, v31
    v_mul_f32 v95, v95, v31
    v_mul_f32 v96, v96, v31
    v_mul_f32 v97, v97, v31
    v_mul_f32 v98, v98, v31
    v_mul_f32 v99, v99, v31
    v_mul_f32 v100, v100, v31
    v_mul_f32 v101, v101, v31
    v_mul_f32 v102, v102, v31
    v_mul_f32 v103, v103, v31
    v_mul_f32 v104, v104, v31
    v_mul_f32 v105, v105, v31
    v_mul_f32 v106, v106, v31
    v_mul_f32 v107, v107, v31
    v_mul_f32 v108, v108, v31
    v_mul_f32 v109, v109, v31
    v_mul_f32 v110, v110, v31
    v_mul_f32 v111, v111, v31
    v_mul_f32 v112, v112, v31
    v_mul_f32 v113, v113, v31
    v_mul_f32 v114, v114, v31
    v_mul_f32 v115, v115, v31
    v_mul_f32 v116, v116, v31
    v_mul_f32 v117, v117, v31
    v_mul_f32 v118, v118, v31
    v_mul_f32 v119, v119, v31
    v_mul_f32 v120, v120, v31
    v_mul_f32 v121, v121, v31
    v_mul_f32 v122, v122, v31
    v_mul_f32 v123, v123, v31
    v_mul_f32 v124, v124, v31
    v_mul_f32 v125, v125, v31
    v_mul_f32 v126, v126, v31
    v_mul_f32 v127, v127, v31
    v_sub_f32 v232, 0, v28
    v_sub_f32 v233, 0, v28
    v_sub_f32 v234, 0, v28
    v_sub_f32 v235, 0, v28
    v_sub_f32 v236, 0, v28
    v_sub_f32 v237, 0, v28
    v_sub_f32 v238, 0, v28
    v_sub_f32 v239, 0, v28
    v_sub_f32 v240, 0, v28
    v_sub_f32 v241, 0, v28
    v_sub_f32 v242, 0, v28
    v_sub_f32 v243, 0, v28
    v_sub_f32 v244, 0, v28
    v_sub_f32 v245, 0, v28
    v_sub_f32 v246, 0, v28
    v_sub_f32 v247, 0, v28
attn_kernel_nr4:
    v_exp_f32 v128, v128
    v_exp_f32 v129, v129
    v_exp_f32 v130, v130
    v_exp_f32 v131, v131
    v_add_f32 v29, v29, v128
    v_add_f32 v29, v29, v129
    v_cvt_pk_bf16_f32 v176, v128, v129
    v_exp_f32 v132, v132
    v_exp_f32 v133, v133
    v_add_f32 v29, v29, v130
    v_add_f32 v29, v29, v131
    v_cvt_pk_bf16_f32 v177, v130, v131
    v_exp_f32 v134, v134
    v_exp_f32 v135, v135
    v_add_f32 v29, v29, v132
    v_add_f32 v29, v29, v133
    v_cvt_pk_bf16_f32 v178, v132, v133
    v_exp_f32 v136, v136
    v_exp_f32 v137, v137
    v_add_f32 v29, v29, v134
    v_add_f32 v29, v29, v135
    v_cvt_pk_bf16_f32 v179, v134, v135
    v_exp_f32 v138, v138
    v_exp_f32 v139, v139
    v_add_f32 v29, v29, v136
    v_add_f32 v29, v29, v137
    v_cvt_pk_bf16_f32 v180, v136, v137
    v_exp_f32 v140, v140
    v_exp_f32 v141, v141
    v_add_f32 v29, v29, v138
    v_add_f32 v29, v29, v139
    v_cvt_pk_bf16_f32 v181, v138, v139
    v_exp_f32 v142, v142
    v_exp_f32 v143, v143
    v_add_f32 v29, v29, v140
    v_add_f32 v29, v29, v141
    v_cvt_pk_bf16_f32 v182, v140, v141
    v_exp_f32 v144, v144
    v_exp_f32 v145, v145
    v_add_f32 v29, v29, v142
    v_add_f32 v29, v29, v143
    v_cvt_pk_bf16_f32 v183, v142, v143
    v_exp_f32 v146, v146
    v_exp_f32 v147, v147
    v_add_f32 v29, v29, v144
    v_add_f32 v29, v29, v145
    v_cvt_pk_bf16_f32 v184, v144, v145
    v_exp_f32 v148, v148
    v_exp_f32 v149, v149
    v_add_f32 v29, v29, v146
    v_add_f32 v29, v29, v147
    v_cvt_pk_bf16_f32 v185, v146, v147
    v_exp_f32 v150, v150
    v_exp_f32 v151, v151
    v_add_f32 v29, v29, v148
    v_add_f32 v29, v29, v149
    v_cvt_pk_bf16_f32 v186, v148, v149
    v_exp_f32 v152, v152
    v_exp_f32 v153, v153
    v_add_f32 v29, v29, v150
    v_add_f32 v29, v29, v151
    v_cvt_pk_bf16_f32 v187, v150, v151
    v_exp_f32 v154, v154
    v_exp_f32 v155, v155
    v_add_f32 v29, v29, v152
    v_add_f32 v29, v29, v153
    v_cvt_pk_bf16_f32 v188, v152, v153
    v_exp_f32 v156, v156
    v_exp_f32 v157, v157
    v_add_f32 v29, v29, v154
    v_add_f32 v29, v29, v155
    v_cvt_pk_bf16_f32 v189, v154, v155
    v_exp_f32 v158, v158
    v_exp_f32 v159, v159
    v_add_f32 v29, v29, v156
    v_add_f32 v29, v29, v157
    v_cvt_pk_bf16_f32 v190, v156, v157
    v_add_f32 v29, v29, v158
    v_add_f32 v29, v29, v159
    v_cvt_pk_bf16_f32 v191, v158, v159
    s_barrier
    s_add_u32 s49, s49, 2
    s_cmp_lt_u32 s49, 32
    s_cbranch_scc1 attn_kernel_loop
    s_setprio 1
    ds_read_b64_tr_b16 v[192:193], v24 offset:0
    ds_read_b64_tr_b16 v[194:195], v24 offset:2048
    ds_read_b64_tr_b16 v[196:197], v25 offset:0
    ds_read_b64_tr_b16 v[198:199], v25 offset:2048
    ds_read_b64_tr_b16 v[200:201], v26 offset:0
    ds_read_b64_tr_b16 v[202:203], v26 offset:2048
    ds_read_b64_tr_b16 v[204:205], v27 offset:0
    ds_read_b64_tr_b16 v[206:207], v27 offset:2048
    ds_read_b64_tr_b16 v[208:209], v24 offset:4096
    ds_read_b64_tr_b16 v[210:211], v24 offset:6144
    ds_read_b64_tr_b16 v[212:213], v25 offset:4096
    ds_read_b64_tr_b16 v[214:215], v25 offset:6144
    ds_read_b64_tr_b16 v[216:217], v26 offset:4096
    ds_read_b64_tr_b16 v[218:219], v26 offset:6144
    ds_read_b64_tr_b16 v[220:221], v27 offset:4096
    ds_read_b64_tr_b16 v[222:223], v27 offset:6144
    ds_read_b64_tr_b16 v[224:225], v24 offset:8192
    ds_read_b64_tr_b16 v[226:227], v24 offset:10240
    s_waitcnt lgkmcnt(15)
    v_mfma_f32_32x32x16_bf16 v[64:79], v[192:195], v[176:179], v[64:79]
    ds_read_b64_tr_b16 v[228:229], v25 offset:8192
    ds_read_b64_tr_b16 v[230:231], v25 offset:10240
    s_waitcnt lgkmcnt(15)
    v_mfma_f32_32x32x16_bf16 v[80:95], v[196:199], v[176:179], v[80:95]
    ds_read_b64_tr_b16 v[192:193], v26 offset:8192
    ds_read_b64_tr_b16 v[194:195], v26 offset:10240
    s_waitcnt lgkmcnt(15)
    v_mfma_f32_32x32x16_bf16 v[96:111], v[200:203], v[176:179], v[96:111]
    ds_read_b64_tr_b16 v[196:197], v27 offset:8192
    ds_read_b64_tr_b16 v[198:199], v27 offset:10240
    s_waitcnt lgkmcnt(15)
    v_mfma_f32_32x32x16_bf16 v[112:127], v[204:207], v[176:179], v[112:127]
    ds_read_b64_tr_b16 v[200:201], v24 offset:12288
    ds_read_b64_tr_b16 v[202:203], v24 offset:14336
    s_waitcnt lgkmcnt(15)
    v_mfma_f32_32x32x16_bf16 v[64:79], v[208:211], v[180:183], v[64:79]
    ds_read_b64_tr_b16 v[204:205], v25 offset:12288
    ds_read_b64_tr_b16 v[206:207], v25 offset:14336
    s_waitcnt lgkmcnt(15)
    v_mfma_f32_32x32x16_bf16 v[80:95], v[212:215], v[180:183], v[80:95]
    ds_read_b64_tr_b16 v[208:209], v26 offset:12288
    ds_read_b64_tr_b16 v[210:211], v26 offset:14336
    s_waitcnt lgkmcnt(15)
    v_mfma_f32_32x32x16_bf16 v[96:111], v[216:219], v[180:183], v[96:111]
    ds_read_b64_tr_b16 v[212:213], v27 offset:12288
    ds_read_b64_tr_b16 v[214:215], v27 offset:14336
    s_waitcnt lgkmcnt(15)
    v_mfma_f32_32x32x16_bf16 v[112:127], v[220:223], v[180:183], v[112:127]
    s_waitcnt lgkmcnt(14)
    v_mfma_f32_32x32x16_bf16 v[64:79], v[224:227], v[184:187], v[64:79]
    s_waitcnt lgkmcnt(12)
    v_mfma_f32_32x32x16_bf16 v[80:95], v[228:231], v[184:187], v[80:95]
    s_waitcnt lgkmcnt(10)
    v_mfma_f32_32x32x16_bf16 v[96:111], v[192:195], v[184:187], v[96:111]
    s_waitcnt lgkmcnt(8)
    v_mfma_f32_32x32x16_bf16 v[112:127], v[196:199], v[184:187], v[112:127]
    s_waitcnt lgkmcnt(6)
    v_mfma_f32_32x32x16_bf16 v[64:79], v[200:203], v[188:191], v[64:79]
    s_waitcnt lgkmcnt(4)
    v_mfma_f32_32x32x16_bf16 v[80:95], v[204:207], v[188:191], v[80:95]
    s_waitcnt lgkmcnt(2)
    v_mfma_f32_32x32x16_bf16 v[96:111], v[208:211], v[188:191], v[96:111]
    s_waitcnt lgkmcnt(0)
    v_mfma_f32_32x32x16_bf16 v[112:127], v[212:215], v[188:191], v[112:127]
    s_setprio 0
    s_cmp_ge_u32 s50, 4
    s_cbranch_scc1 attn_kernel_nostag2
    s_barrier
attn_kernel_nostag2:
    s_nop 7
    s_nop 7
    v_mov_b32 v31, v29
    s_nop 1
    v_permlane32_swap_b32 v29, v31
    v_add_f32 v29, v29, v31
    v_rcp_f32 v29, v29
    v_lshlrev_b32 v6, 3, v4
    v_add_u32 v6, v5, v6
    v_mul_f32 v64, v64, v29
    v_mul_f32 v65, v65, v29
    v_mul_f32 v66, v66, v29
    v_mul_f32 v67, v67, v29
    v_cvt_pk_bf16_f32 v8, v64, v65
    v_cvt_pk_bf16_f32 v9, v66, v67
    buffer_store_dwordx2 v[8:9], v6, s[24:27], 0 offen offset:0
    s_nop 1
    v_mul_f32 v68, v68, v29
    v_mul_f32 v69, v69, v29
    v_mul_f32 v70, v70, v29
    v_mul_f32 v71, v71, v29
    v_cvt_pk_bf16_f32 v8, v68, v69
    v_cvt_pk_bf16_f32 v9, v70, v71
    buffer_store_dwordx2 v[8:9], v6, s[24:27], 0 offen offset:16
    s_nop 1
    v_mul_f32 v72, v72, v29
    v_mul_f32 v73, v73, v29
    v_mul_f32 v74, v74, v29
    v_mul_f32 v75, v75, v29
    v_cvt_pk_bf16_f32 v8, v72, v73
    v_cvt_pk_bf16_f32 v9, v74, v75
    buffer_store_dwordx2 v[8:9], v6, s[24:27], 0 offen offset:32
    s_nop 1
    v_mul_f32 v76, v76, v29
    v_mul_f32 v77, v77, v29
    v_mul_f32 v78, v78, v29
    v_mul_f32 v79, v79, v29
    v_cvt_pk_bf16_f32 v8, v76, v77
    v_cvt_pk_bf16_f32 v9, v78, v79
    buffer_store_dwordx2 v[8:9], v6, s[24:27], 0 offen offset:48
    s_nop 1
    v_mul_f32 v80, v80, v29
    v_mul_f32 v81, v81, v29
    v_mul_f32 v82, v82, v29
    v_mul_f32 v83, v83, v29
    v_cvt_pk_bf16_f32 v8, v80, v81
    v_cvt_pk_bf16_f32 v9, v82, v83
    buffer_store_dwordx2 v[8:9], v6, s[24:27], 0 offen offset:64
    s_nop 1
    v_mul_f32 v84, v84, v29
    v_mul_f32 v85, v85, v29
    v_mul_f32 v86, v86, v29
    v_mul_f32 v87, v87, v29
    v_cvt_pk_bf16_f32 v8, v84, v85
    v_cvt_pk_bf16_f32 v9, v86, v87
    buffer_store_dwordx2 v[8:9], v6, s[24:27], 0 offen offset:80
    s_nop 1
    v_mul_f32 v88, v88, v29
    v_mul_f32 v89, v89, v29
    v_mul_f32 v90, v90, v29
    v_mul_f32 v91, v91, v29
    v_cvt_pk_bf16_f32 v8, v88, v89
    v_cvt_pk_bf16_f32 v9, v90, v91
    buffer_store_dwordx2 v[8:9], v6, s[24:27], 0 offen offset:96
    s_nop 1
    v_mul_f32 v92, v92, v29
    v_mul_f32 v93, v93, v29
    v_mul_f32 v94, v94, v29
    v_mul_f32 v95, v95, v29
    v_cvt_pk_bf16_f32 v8, v92, v93
    v_cvt_pk_bf16_f32 v9, v94, v95
    buffer_store_dwordx2 v[8:9], v6, s[24:27], 0 offen offset:112
    s_nop 1
    v_mul_f32 v96, v96, v29
    v_mul_f32 v97, v97, v29
    v_mul_f32 v98, v98, v29
    v_mul_f32 v99, v99, v29
    v_cvt_pk_bf16_f32 v8, v96, v97
    v_cvt_pk_bf16_f32 v9, v98, v99
    buffer_store_dwordx2 v[8:9], v6, s[24:27], 0 offen offset:128
    s_nop 1
    v_mul_f32 v100, v100, v29
    v_mul_f32 v101, v101, v29
    v_mul_f32 v102, v102, v29
    v_mul_f32 v103, v103, v29
    v_cvt_pk_bf16_f32 v8, v100, v101
    v_cvt_pk_bf16_f32 v9, v102, v103
    buffer_store_dwordx2 v[8:9], v6, s[24:27], 0 offen offset:144
    s_nop 1
    v_mul_f32 v104, v104, v29
    v_mul_f32 v105, v105, v29
    v_mul_f32 v106, v106, v29
    v_mul_f32 v107, v107, v29
    v_cvt_pk_bf16_f32 v8, v104, v105
    v_cvt_pk_bf16_f32 v9, v106, v107
    buffer_store_dwordx2 v[8:9], v6, s[24:27], 0 offen offset:160
    s_nop 1
    v_mul_f32 v108, v108, v29
    v_mul_f32 v109, v109, v29
    v_mul_f32 v110, v110, v29
    v_mul_f32 v111, v111, v29
    v_cvt_pk_bf16_f32 v8, v108, v109
    v_cvt_pk_bf16_f32 v9, v110, v111
    buffer_store_dwordx2 v[8:9], v6, s[24:27], 0 offen offset:176
    s_nop 1
    v_mul_f32 v112, v112, v29
    v_mul_f32 v113, v113, v29
    v_mul_f32 v114, v114, v29
    v_mul_f32 v115, v115, v29
    v_cvt_pk_bf16_f32 v8, v112, v113
    v_cvt_pk_bf16_f32 v9, v114, v115
    buffer_store_dwordx2 v[8:9], v6, s[24:27], 0 offen offset:192
    s_nop 1
    v_mul_f32 v116, v116, v29
    v_mul_f32 v117, v117, v29
    v_mul_f32 v118, v118, v29
    v_mul_f32 v119, v119, v29
    v_cvt_pk_bf16_f32 v8, v116, v117
    v_cvt_pk_bf16_f32 v9, v118, v119
    buffer_store_dwordx2 v[8:9], v6, s[24:27], 0 offen offset:208
    s_nop 1
    v_mul_f32 v120, v120, v29
    v_mul_f32 v121, v121, v29
    v_mul_f32 v122, v122, v29
    v_mul_f32 v123, v123, v29
    v_cvt_pk_bf16_f32 v8, v120, v121
    v_cvt_pk_bf16_f32 v9, v122, v123
    buffer_store_dwordx2 v[8:9], v6, s[24:27], 0 offen offset:224
    s_nop 1
    v_mul_f32 v124, v124, v29
    v_mul_f32 v125, v125, v29
    v_mul_f32 v126, v126, v29
    v_mul_f32 v127, v127, v29
    v_cvt_pk_bf16_f32 v8, v124, v125
    v_cvt_pk_bf16_f32 v9, v126, v127
    buffer_store_dwordx2 v[8:9], v6, s[24:27], 0 offen offset:240
    s_nop 1
attn_kernel_done:
    s_endpgm
.globl wo_kernel
.p2align 8
.type wo_kernel,@function
wo_kernel:
    s_cmp_ge_u32 s2, 256
    s_cbranch_scc1 wo_kernel_done
    s_load_dwordx2 s[4:5], s[0:1], 32
    s_load_dwordx2 s[6:7], s[0:1], 32
    s_load_dwordx2 s[8:9], s[0:1], 104
    s_and_b32 s40, s2, 15
    s_lshr_b32 s41, s2, 4
    s_and_b32 s42, s41, 1
    s_lshr_b32 s43, s41, 1
    v_and_b32 v1, 63, v0
    v_lshrrev_b32 v2, 6, v0
    s_nop 0
    v_readfirstlane_b32 s50, v2
    s_waitcnt lgkmcnt(0)
    s_add_u32 s12, s8, 17825792
    s_addc_u32 s13, s9, 0
    s_mov_b32 s14, 16777216
    s_mov_b32 s15, 0x00020000
    s_mov_b32 s16, s4
    s_mov_b32 s17, s5
    s_mov_b32 s18, 4194304
    s_mov_b32 s19, 0x00020000
    s_mov_b32 s20, s6
    s_mov_b32 s21, s7
    s_mov_b32 s22, 4194304
    s_mov_b32 s23, 0x00020000
    v_lshrrev_b32 v3, 3, v1
    v_lshlrev_b32 v4, 3, v2
    v_add_u32 v3, v3, v4
    v_lshrrev_b32 v5, 1, v3
    v_and_b32 v5, 7, v5
    v_and_b32 v4, 7, v1
    v_xor_b32 v4, v4, v5
    s_lshl_b32 s44, s40, 7
    v_add_u32 v5, s44, v3
    s_mov_b32 s45, 8192
    v_mul_lo_u32 v5, v5, s45
    v_lshlrev_b32 v6, 4, v4
    v_add_u32 v5, v5, v6
    s_mul_i32 s46, s43, 1024
    v_add_u32 v10, s46, v5
    v_add_u32 v11, 524288, v10
    s_lshl_b32 s51, s50, 10
    v_lshrrev_b32 v3, 5, v1
    v_lshlrev_b32 v4, 1, v2
    v_add_u32 v3, v3, v4
    v_and_b32 v5, 3, v3
    v_lshlrev_b32 v5, 2, v5
    v_and_b32 v4, 31, v1
    v_xor_b32 v4, v4, v5
    s_mul_i32 s46, s43, 512
    v_add_u32 v5, s46, v3
    s_mov_b32 s45, 1024
    v_mul_lo_u32 v5, v5, s45
    v_lshlrev_b32 v6, 4, v4
    v_add_u32 v5, v5, v6
    s_lshl_b32 s46, s42, 9
    v_add_u32 v13, s46, v5
    v_add_u32 v14, 16384, v13
    v_add_u32 v15, 32768, v13
    v_add_u32 v16, 49152, v13
    v_and_b32 v3, 31, v1
    v_and_b32 v4, 1, v2
    v_lshlrev_b32 v4, 6, v4
    v_add_u32 v4, v4, v3
    v_lshrrev_b32 v5, 1, v4
    v_and_b32 v5, 7, v5
    v_lshrrev_b32 v6, 5, v1
    v_lshlrev_b32 v7, 7, v4
    v_add_u32 v8, 0, v6
    v_xor_b32 v8, v8, v5
    v_lshlrev_b32 v8, 4, v8
    v_add_u32 v20, v7, v8
    v_add_u32 v8, 2, v6
    v_xor_b32 v8, v8, v5
    v_lshlrev_b32 v8, 4, v8
    v_add_u32 v21, v7, v8
    v_add_u32 v8, 4, v6
    v_xor_b32 v8, v8, v5
    v_lshlrev_b32 v8, 4, v8
    v_add_u32 v22, v7, v8
    v_add_u32 v8, 6, v6
    v_xor_b32 v8, v8, v5
    v_lshlrev_b32 v8, 4, v8
    v_add_u32 v23, v7, v8
    v_lshrrev_b32 v3, 4, v1
    v_and_b32 v4, 15, v1
    v_lshrrev_b32 v5, 1, v2
    v_lshlrev_b32 v5, 3, v5
    v_and_b32 v6, 1, v3
    v_lshlrev_b32 v6, 1, v6
    v_add_u32 v5, v5, v6
    v_and_b32 v6, 3, v4
    v_lshrrev_b32 v6, 1, v6
    v_add_u32 v5, v5, v6
    v_lshrrev_b32 v6, 2, v4
    v_lshrrev_b32 v7, 1, v3
    v_lshlrev_b32 v7, 3, v7
    v_add_u32 v7, v7, v6
    v_lshlrev_b32 v7, 9, v7
    v_and_b32 v8, 1, v4
    v_lshlrev_b32 v8, 3, v8
    v_add_u32 v7, v7, v8
    v_lshlrev_b32 v6, 2, v6
    v_add_u32 v8, 0, v5
    v_xor_b32 v8, v8, v6
    v_lshlrev_b32 v8, 4, v8
    v_add_u32 v8, v8, v7
    v_add_u32 v24, 16384, v8
    v_add_u32 v8, 4, v5
    v_xor_b32 v8, v8, v6
    v_lshlrev_b32 v8, 4, v8
    v_add_u32 v8, v8, v7
    v_add_u32 v25, 16384, v8
    v_add_u32 v28, 49152, v20
    v_add_u32 v29, 49152, v21
    v_add_u32 v30, 49152, v22
    v_add_u32 v31, 49152, v23
    v_add_u32 v32, 49152, v24
    v_add_u32 v33, 49152, v25
    v_add_u32 v36, 98304, v20
    v_add_u32 v37, 98304, v21
    v_add_u32 v38, 98304, v22
    v_add_u32 v39, 98304, v23
    v_add_u32 v40, 98304, v24
    v_add_u32 v41, 98304, v25
    v_mov_b32 v64, 0
    v_mov_b32 v65, 0
    v_mov_b32 v66, 0
    v_mov_b32 v67, 0
    v_mov_b32 v68, 0
    v_mov_b32 v69, 0
    v_mov_b32 v70, 0
    v_mov_b32 v71, 0
    v_mov_b32 v72, 0
    v_mov_b32 v73, 0
    v_mov_b32 v74, 0
    v_mov_b32 v75, 0
    v_mov_b32 v76, 0
    v_mov_b32 v77, 0
    v_mov_b32 v78, 0
    v_mov_b32 v79, 0
    v_mov_b32 v80, 0
    v_mov_b32 v81, 0
    v_mov_b32 v82, 0
    v_mov_b32 v83, 0
    v_mov_b32 v84, 0
    v_mov_b32 v85, 0
    v_mov_b32 v86, 0
    v_mov_b32 v87, 0
    v_mov_b32 v88, 0
    v_mov_b32 v89, 0
    v_mov_b32 v90, 0
    v_mov_b32 v91, 0
    v_mov_b32 v92, 0
    v_mov_b32 v93, 0
    v_mov_b32 v94, 0
    v_mov_b32 v95, 0
    v_mov_b32 v96, 0
    v_mov_b32 v97, 0
    v_mov_b32 v98, 0
    v_mov_b32 v99, 0
    v_mov_b32 v100, 0
    v_mov_b32 v101, 0
    v_mov_b32 v102, 0
    v_mov_b32 v103, 0
    v_mov_b32 v104, 0
    v_mov_b32 v105, 0
    v_mov_b32 v106, 0
    v_mov_b32 v107, 0
    v_mov_b32 v108, 0
    v_mov_b32 v109, 0
    v_mov_b32 v110, 0
    v_mov_b32 v111, 0
    v_mov_b32 v112, 0
    v_mov_b32 v113, 0
    v_mov_b32 v114, 0
    v_mov_b32 v115, 0
    v_mov_b32 v116, 0
    v_mov_b32 v117, 0
    v_mov_b32 v118, 0
    v_mov_b32 v119, 0
    v_mov_b32 v120, 0
    v_mov_b32 v121, 0
    v_mov_b32 v122, 0
    v_mov_b32 v123, 0
    v_mov_b32 v124, 0
    v_mov_b32 v125, 0
    v_mov_b32 v126, 0
    v_mov_b32 v127, 0
    s_mov_b32 s47, 0
    s_mov_b32 s48, 0
    s_add_u32 m0, s51, 0
    s_nop 0
    buffer_load_dwordx4 v10, s[12:15], s47 offen lds
    s_add_u32 m0, s51, 8192
    s_nop 0
    buffer_load_dwordx4 v11, s[12:15], s47 offen lds
    s_add_u32 m0, s51, 16384
    s_nop 0
    buffer_load_dwordx4 v13, s[16:19], s48 offen lds
    s_add_u32 m0, s51, 24576
    s_nop 0
    buffer_load_dwordx4 v14, s[16:19], s48 offen lds
    s_add_u32 m0, s51, 32768
    s_nop 0
    buffer_load_dwordx4 v15, s[16:19], s48 offen lds
    s_add_u32 m0, s51, 40960
    s_nop 0
    buffer_load_dwordx4 v16, s[16:19], s48 offen lds
    s_mov_b32 s47, 128
    s_mov_b32 s48, 65536
    s_add_u32 m0, s51, 49152
    s_nop 0
    buffer_load_dwordx4 v10, s[12:15], s47 offen lds
    s_add_u32 m0, s51, 57344
    s_nop 0
    buffer_load_dwordx4 v11, s[12:15], s47 offen lds
    s_add_u32 m0, s51, 65536
    s_nop 0
    buffer_load_dwordx4 v13, s[16:19], s48 offen lds
    s_add_u32 m0, s51, 73728
    s_nop 0
    buffer_load_dwordx4 v14, s[16:19], s48 offen lds
    s_add_u32 m0, s51, 81920
    s_nop 0
    buffer_load_dwordx4 v15, s[16:19], s48 offen lds
    s_add_u32 m0, s51, 90112
    s_nop 0
    buffer_load_dwordx4 v16, s[16:19], s48 offen lds
    s_waitcnt vmcnt(6)
    s_barrier
    s_mov_b32 s47, 256
    s_mov_b32 s48, 131072
    s_add_u32 m0, s51, 98304
    s_nop 0
    buffer_load_dwordx4 v10, s[12:15], s47 offen lds
    s_add_u32 m0, s51, 106496
    s_nop 0
    buffer_load_dwordx4 v11, s[12:15], s47 offen lds
    s_add_u32 m0, s51, 114688
    s_nop 0
    buffer_load_dwordx4 v13, s[16:19], s48 offen lds
    s_add_u32 m0, s51, 122880
    s_nop 0
    buffer_load_dwordx4 v14, s[16:19], s48 offen lds
    s_add_u32 m0, s51, 131072
    s_nop 0
    buffer_load_dwordx4 v15, s[16:19], s48 offen lds
    s_add_u32 m0, s51, 139264
    s_nop 0
    buffer_load_dwordx4 v16, s[16:19], s48 offen lds
    ds_read_b128 v[128:131], v20 offset:0
    ds_read_b128 v[132:135], v20 offset:4096
    ds_read_b64_tr_b16 v[136:137], v24 offset:0
    ds_read_b64_tr_b16 v[138:139], v24 offset:2048
    ds_read_b64_tr_b16 v[140:141], v25 offset:0
    ds_read_b64_tr_b16 v[142:143], v25 offset:2048
    ds_read_b128 v[144:147], v21 offset:0
    ds_read_b128 v[148:151], v21 offset:4096
    ds_read_b64_tr_b16 v[152:153], v24 offset:8192
    ds_read_b64_tr_b16 v[154:155], v24 offset:10240
    ds_read_b64_tr_b16 v[156:157], v25 offset:8192
    ds_read_b64_tr_b16 v[158:159], v25 offset:10240
    ds_read_b128 v[160:163], v22 offset:0
    ds_read_b128 v[164:167], v22 offset:4096
    ds_read_b64_tr_b16 v[168:169], v24 offset:16384
    ds_read_b64_tr_b16 v[170:171], v24 offset:18432
    ds_read_b64_tr_b16 v[172:173], v25 offset:16384
    ds_read_b64_tr_b16 v[174:175], v25 offset:18432
    s_waitcnt lgkmcnt(12)
    v_mfma_f32_32x32x16_bf16 v[64:79], v[136:139], v[128:131], v[64:79]
    v_mfma_f32_32x32x16_bf16 v[80:95], v[136:139], v[132:135], v[80:95]
    v_mfma_f32_32x32x16_bf16 v[96:111], v[140:143], v[128:131], v[96:111]
    v_mfma_f32_32x32x16_bf16 v[112:127], v[140:143], v[132:135], v[112:127]
    ds_read_b128 v[128:131], v23 offset:0
    ds_read_b128 v[132:135], v23 offset:4096
    ds_read_b64_tr_b16 v[136:137], v24 offset:24576
    ds_read_b64_tr_b16 v[138:139], v24 offset:26624
    ds_read_b64_tr_b16 v[140:141], v25 offset:24576
    ds_read_b64_tr_b16 v[142:143], v25 offset:26624
    s_waitcnt lgkmcnt(12)
    v_mfma_f32_32x32x16_bf16 v[64:79], v[152:155], v[144:147], v[64:79]
    v_mfma_f32_32x32x16_bf16 v[80:95], v[152:155], v[148:151], v[80:95]
    v_mfma_f32_32x32x16_bf16 v[96:111], v[156:159], v[144:147], v[96:111]
    v_mfma_f32_32x32x16_bf16 v[112:127], v[156:159], v[148:151], v[112:127]
    s_waitcnt lgkmcnt(6)
    v_mfma_f32_32x32x16_bf16 v[64:79], v[168:171], v[160:163], v[64:79]
    v_mfma_f32_32x32x16_bf16 v[80:95], v[168:171], v[164:167], v[80:95]
    v_mfma_f32_32x32x16_bf16 v[96:111], v[172:175], v[160:163], v[96:111]
    v_mfma_f32_32x32x16_bf16 v[112:127], v[172:175], v[164:167], v[112:127]
    s_waitcnt lgkmcnt(0)
    v_mfma_f32_32x32x16_bf16 v[64:79], v[136:139], v[128:131], v[64:79]
    v_mfma_f32_32x32x16_bf16 v[80:95], v[136:139], v[132:135], v[80:95]
    v_mfma_f32_32x32x16_bf16 v[96:111], v[140:143], v[128:131], v[96:111]
    v_mfma_f32_32x32x16_bf16 v[112:127], v[140:143], v[132:135], v[112:127]
    s_waitcnt vmcnt(6)
    s_barrier
    s_mov_b32 s47, 384
    s_mov_b32 s48, 196608
    s_add_u32 m0, s51, 0
    s_nop 0
    buffer_load_dwordx4 v10, s[12:15], s47 offen lds
    s_add_u32 m0, s51, 8192
    s_nop 0
    buffer_load_dwordx4 v11, s[12:15], s47 offen lds
    s_add_u32 m0, s51, 16384
    s_nop 0
    buffer_load_dwordx4 v13, s[16:19], s48 offen lds
    s_add_u32 m0, s51, 24576
    s_nop 0
    buffer_load_dwordx4 v14, s[16:19], s48 offen lds
    s_add_u32 m0, s51, 32768
    s_nop 0
    buffer_load_dwordx4 v15, s[16:19], s48 offen lds
    s_add_u32 m0, s51, 40960
    s_nop 0
    buffer_load_dwordx4 v16, s[16:19], s48 offen lds
    ds_read_b128 v[128:131], v28 offset:0
    ds_read_b128 v[132:135], v28 offset:4096
    ds_read_b64_tr_b16 v[136:137], v32 offset:0
    ds_read_b64_tr_b16 v[138:139], v32 offset:2048
    ds_read_b64_tr_b16 v[140:141], v33 offset:0
    ds_read_b64_tr_b16 v[142:143], v33 offset:2048
    ds_read_b128 v[144:147], v29 offset:0
    ds_read_b128 v[148:151], v29 offset:4096
    ds_read_b64_tr_b16 v[152:153], v32 offset:8192
    ds_read_b64_tr_b16 v[154:155], v32 offset:10240
    ds_read_b64_tr_b16 v[156:157], v33 offset:8192
    ds_read_b64_tr_b16 v[158:159], v33 offset:10240
    ds_read_b128 v[160:163], v30 offset:0
    ds_read_b128 v[164:167], v30 offset:4096
    ds_read_b64_tr_b16 v[168:169], v32 offset:16384
    ds_read_b64_tr_b16 v[170:171], v32 offset:18432
    ds_read_b64_tr_b16 v[172:173], v33 offset:16384
    ds_read_b64_tr_b16 v[174:175], v33 offset:18432
    s_waitcnt lgkmcnt(12)
    v_mfma_f32_32x32x16_bf16 v[64:79], v[136:139], v[128:131], v[64:79]
    v_mfma_f32_32x32x16_bf16 v[80:95], v[136:139], v[132:135], v[80:95]
    v_mfma_f32_32x32x16_bf16 v[96:111], v[140:143], v[128:131], v[96:111]
    v_mfma_f32_32x32x16_bf16 v[112:127], v[140:143], v[132:135], v[112:127]
    ds_read_b128 v[128:131], v31 offset:0
    ds_read_b128 v[132:135], v31 offset:4096
    ds_read_b64_tr_b16 v[136:137], v32 offset:24576
    ds_read_b64_tr_b16 v[138:139], v32 offset:26624
    ds_read_b64_tr_b16 v[140:141], v33 offset:24576
    ds_read_b64_tr_b16 v[142:143], v33 offset:26624
    s_waitcnt lgkmcnt(12)
    v_mfma_f32_32x32x16_bf16 v[64:79], v[152:155], v[144:147], v[64:79]
    v_mfma_f32_32x32x16_bf16 v[80:95], v[152:155], v[148:151], v[80:95]
    v_mfma_f32_32x32x16_bf16 v[96:111], v[156:159], v[144:147], v[96:111]
    v_mfma_f32_32x32x16_bf16 v[112:127], v[156:159], v[148:151], v[112:127]
    s_waitcnt lgkmcnt(6)
    v_mfma_f32_32x32x16_bf16 v[64:79], v[168:171], v[160:163], v[64:79]
    v_mfma_f32_32x32x16_bf16 v[80:95], v[168:171], v[164:167], v[80:95]
    v_mfma_f32_32x32x16_bf16 v[96:111], v[172:175], v[160:163], v[96:111]
    v_mfma_f32_32x32x16_bf16 v[112:127], v[172:175], v[164:167], v[112:127]
    s_waitcnt lgkmcnt(0)
    v_mfma_f32_32x32x16_bf16 v[64:79], v[136:139], v[128:131], v[64:79]
    v_mfma_f32_32x32x16_bf16 v[80:95], v[136:139], v[132:135], v[80:95]
    v_mfma_f32_32x32x16_bf16 v[96:111], v[140:143], v[128:131], v[96:111]
    v_mfma_f32_32x32x16_bf16 v[112:127], v[140:143], v[132:135], v[112:127]
    s_waitcnt vmcnt(6)
    s_barrier
    s_mov_b32 s47, 512
    s_mov_b32 s48, 262144
    s_add_u32 m0, s51, 49152
    s_nop 0
    buffer_load_dwordx4 v10, s[12:15], s47 offen lds
    s_add_u32 m0, s51, 57344
    s_nop 0
    buffer_load_dwordx4 v11, s[12:15], s47 offen lds
    s_add_u32 m0, s51, 65536
    s_nop 0
    buffer_load_dwordx4 v13, s[16:19], s48 offen lds
    s_add_u32 m0, s51, 73728
    s_nop 0
    buffer_load_dwordx4 v14, s[16:19], s48 offen lds
    s_add_u32 m0, s51, 81920
    s_nop 0
    buffer_load_dwordx4 v15, s[16:19], s48 offen lds
    s_add_u32 m0, s51, 90112
    s_nop 0
    buffer_load_dwordx4 v16, s[16:19], s48 offen lds
    ds_read_b128 v[128:131], v36 offset:0
    ds_read_b128 v[132:135], v36 offset:4096
    ds_read_b64_tr_b16 v[136:137], v40 offset:0
    ds_read_b64_tr_b16 v[138:139], v40 offset:2048
    ds_read_b64_tr_b16 v[140:141], v41 offset:0
    ds_read_b64_tr_b16 v[142:143], v41 offset:2048
    ds_read_b128 v[144:147], v37 offset:0
    ds_read_b128 v[148:151], v37 offset:4096
    ds_read_b64_tr_b16 v[152:153], v40 offset:8192
    ds_read_b64_tr_b16 v[154:155], v40 offset:10240
    ds_read_b64_tr_b16 v[156:157], v41 offset:8192
    ds_read_b64_tr_b16 v[158:159], v41 offset:10240
    ds_read_b128 v[160:163], v38 offset:0
    ds_read_b128 v[164:167], v38 offset:4096
    ds_read_b64_tr_b16 v[168:169], v40 offset:16384
    ds_read_b64_tr_b16 v[170:171], v40 offset:18432
    ds_read_b64_tr_b16 v[172:173], v41 offset:16384
    ds_read_b64_tr_b16 v[174:175], v41 offset:18432
    s_waitcnt lgkmcnt(12)
    v_mfma_f32_32x32x16_bf16 v[64:79], v[136:139], v[128:131], v[64:79]
    v_mfma_f32_32x32x16_bf16 v[80:95], v[136:139], v[132:135], v[80:95]
    v_mfma_f32_32x32x16_bf16 v[96:111], v[140:143], v[128:131], v[96:111]
    v_mfma_f32_32x32x16_bf16 v[112:127], v[140:143], v[132:135], v[112:127]
    ds_read_b128 v[128:131], v39 offset:0
    ds_read_b128 v[132:135], v39 offset:4096
    ds_read_b64_tr_b16 v[136:137], v40 offset:24576
    ds_read_b64_tr_b16 v[138:139], v40 offset:26624
    ds_read_b64_tr_b16 v[140:141], v41 offset:24576
    ds_read_b64_tr_b16 v[142:143], v41 offset:26624
    s_waitcnt lgkmcnt(12)
    v_mfma_f32_32x32x16_bf16 v[64:79], v[152:155], v[144:147], v[64:79]
    v_mfma_f32_32x32x16_bf16 v[80:95], v[152:155], v[148:151], v[80:95]
    v_mfma_f32_32x32x16_bf16 v[96:111], v[156:159], v[144:147], v[96:111]
    v_mfma_f32_32x32x16_bf16 v[112:127], v[156:159], v[148:151], v[112:127]
    s_waitcnt lgkmcnt(6)
    v_mfma_f32_32x32x16_bf16 v[64:79], v[168:171], v[160:163], v[64:79]
    v_mfma_f32_32x32x16_bf16 v[80:95], v[168:171], v[164:167], v[80:95]
    v_mfma_f32_32x32x16_bf16 v[96:111], v[172:175], v[160:163], v[96:111]
    v_mfma_f32_32x32x16_bf16 v[112:127], v[172:175], v[164:167], v[112:127]
    s_waitcnt lgkmcnt(0)
    v_mfma_f32_32x32x16_bf16 v[64:79], v[136:139], v[128:131], v[64:79]
    v_mfma_f32_32x32x16_bf16 v[80:95], v[136:139], v[132:135], v[80:95]
    v_mfma_f32_32x32x16_bf16 v[96:111], v[140:143], v[128:131], v[96:111]
    v_mfma_f32_32x32x16_bf16 v[112:127], v[140:143], v[132:135], v[112:127]
    s_waitcnt vmcnt(6)
    s_barrier
    s_mov_b32 s47, 640
    s_mov_b32 s48, 327680
    s_add_u32 m0, s51, 98304
    s_nop 0
    buffer_load_dwordx4 v10, s[12:15], s47 offen lds
    s_add_u32 m0, s51, 106496
    s_nop 0
    buffer_load_dwordx4 v11, s[12:15], s47 offen lds
    s_add_u32 m0, s51, 114688
    s_nop 0
    buffer_load_dwordx4 v13, s[16:19], s48 offen lds
    s_add_u32 m0, s51, 122880
    s_nop 0
    buffer_load_dwordx4 v14, s[16:19], s48 offen lds
    s_add_u32 m0, s51, 131072
    s_nop 0
    buffer_load_dwordx4 v15, s[16:19], s48 offen lds
    s_add_u32 m0, s51, 139264
    s_nop 0
    buffer_load_dwordx4 v16, s[16:19], s48 offen lds
    ds_read_b128 v[128:131], v20 offset:0
    ds_read_b128 v[132:135], v20 offset:4096
    ds_read_b64_tr_b16 v[136:137], v24 offset:0
    ds_read_b64_tr_b16 v[138:139], v24 offset:2048
    ds_read_b64_tr_b16 v[140:141], v25 offset:0
    ds_read_b64_tr_b16 v[142:143], v25 offset:2048
    ds_read_b128 v[144:147], v21 offset:0
    ds_read_b128 v[148:151], v21 offset:4096
    ds_read_b64_tr_b16 v[152:153], v24 offset:8192
    ds_read_b64_tr_b16 v[154:155], v24 offset:10240
    ds_read_b64_tr_b16 v[156:157], v25 offset:8192
    ds_read_b64_tr_b16 v[158:159], v25 offset:10240
    ds_read_b128 v[160:163], v22 offset:0
    ds_read_b128 v[164:167], v22 offset:4096
    ds_read_b64_tr_b16 v[168:169], v24 offset:16384
    ds_read_b64_tr_b16 v[170:171], v24 offset:18432
    ds_read_b64_tr_b16 v[172:173], v25 offset:16384
    ds_read_b64_tr_b16 v[174:175], v25 offset:18432
    s_waitcnt lgkmcnt(12)
    v_mfma_f32_32x32x16_bf16 v[64:79], v[136:139], v[128:131], v[64:79]
    v_mfma_f32_32x32x16_bf16 v[80:95], v[136:139], v[132:135], v[80:95]
    v_mfma_f32_32x32x16_bf16 v[96:111], v[140:143], v[128:131], v[96:111]
    v_mfma_f32_32x32x16_bf16 v[112:127], v[140:143], v[132:135], v[112:127]
    ds_read_b128 v[128:131], v23 offset:0
    ds_read_b128 v[132:135], v23 offset:4096
    ds_read_b64_tr_b16 v[136:137], v24 offset:24576
    ds_read_b64_tr_b16 v[138:139], v24 offset:26624
    ds_read_b64_tr_b16 v[140:141], v25 offset:24576
    ds_read_b64_tr_b16 v[142:143], v25 offset:26624
    s_waitcnt lgkmcnt(12)
    v_mfma_f32_32x32x16_bf16 v[64:79], v[152:155], v[144:147], v[64:79]
    v_mfma_f32_32x32x16_bf16 v[80:95], v[152:155], v[148:151], v[80:95]
    v_mfma_f32_32x32x16_bf16 v[96:111], v[156:159], v[144:147], v[96:111]
    v_mfma_f32_32x32x16_bf16 v[112:127], v[156:159], v[148:151], v[112:127]
    s_waitcnt lgkmcnt(6)
    v_mfma_f32_32x32x16_bf16 v[64:79], v[168:171], v[160:163], v[64:79]
    v_mfma_f32_32x32x16_bf16 v[80:95], v[168:171], v[164:167], v[80:95]
    v_mfma_f32_32x32x16_bf16 v[96:111], v[172:175], v[160:163], v[96:111]
    v_mfma_f32_32x32x16_bf16 v[112:127], v[172:175], v[164:167], v[112:127]
    s_waitcnt lgkmcnt(0)
    v_mfma_f32_32x32x16_bf16 v[64:79], v[136:139], v[128:131], v[64:79]
    v_mfma_f32_32x32x16_bf16 v[80:95], v[136:139], v[132:135], v[80:95]
    v_mfma_f32_32x32x16_bf16 v[96:111], v[140:143], v[128:131], v[96:111]
    v_mfma_f32_32x32x16_bf16 v[112:127], v[140:143], v[132:135], v[112:127]
    s_waitcnt vmcnt(6)
    s_barrier
    s_mov_b32 s47, 768
    s_mov_b32 s48, 393216
    s_add_u32 m0, s51, 0
    s_nop 0
    buffer_load_dwordx4 v10, s[12:15], s47 offen lds
    s_add_u32 m0, s51, 8192
    s_nop 0
    buffer_load_dwordx4 v11, s[12:15], s47 offen lds
    s_add_u32 m0, s51, 16384
    s_nop 0
    buffer_load_dwordx4 v13, s[16:19], s48 offen lds
    s_add_u32 m0, s51, 24576
    s_nop 0
    buffer_load_dwordx4 v14, s[16:19], s48 offen lds
    s_add_u32 m0, s51, 32768
    s_nop 0
    buffer_load_dwordx4 v15, s[16:19], s48 offen lds
    s_add_u32 m0, s51, 40960
    s_nop 0
    buffer_load_dwordx4 v16, s[16:19], s48 offen lds
    ds_read_b128 v[128:131], v28 offset:0
    ds_read_b128 v[132:135], v28 offset:4096
    ds_read_b64_tr_b16 v[136:137], v32 offset:0
    ds_read_b64_tr_b16 v[138:139], v32 offset:2048
    ds_read_b64_tr_b16 v[140:141], v33 offset:0
    ds_read_b64_tr_b16 v[142:143], v33 offset:2048
    ds_read_b128 v[144:147], v29 offset:0
    ds_read_b128 v[148:151], v29 offset:4096
    ds_read_b64_tr_b16 v[152:153], v32 offset:8192
    ds_read_b64_tr_b16 v[154:155], v32 offset:10240
    ds_read_b64_tr_b16 v[156:157], v33 offset:8192
    ds_read_b64_tr_b16 v[158:159], v33 offset:10240
    ds_read_b128 v[160:163], v30 offset:0
    ds_read_b128 v[164:167], v30 offset:4096
    ds_read_b64_tr_b16 v[168:169], v32 offset:16384
    ds_read_b64_tr_b16 v[170:171], v32 offset:18432
    ds_read_b64_tr_b16 v[172:173], v33 offset:16384
    ds_read_b64_tr_b16 v[174:175], v33 offset:18432
    s_waitcnt lgkmcnt(12)
    v_mfma_f32_32x32x16_bf16 v[64:79], v[136:139], v[128:131], v[64:79]
    v_mfma_f32_32x32x16_bf16 v[80:95], v[136:139], v[132:135], v[80:95]
    v_mfma_f32_32x32x16_bf16 v[96:111], v[140:143], v[128:131], v[96:111]
    v_mfma_f32_32x32x16_bf16 v[112:127], v[140:143], v[132:135], v[112:127]
    ds_read_b128 v[128:131], v31 offset:0
    ds_read_b128 v[132:135], v31 offset:4096
    ds_read_b64_tr_b16 v[136:137], v32 offset:24576
    ds_read_b64_tr_b16 v[138:139], v32 offset:26624
    ds_read_b64_tr_b16 v[140:141], v33 offset:24576
    ds_read_b64_tr_b16 v[142:143], v33 offset:26624
    s_waitcnt lgkmcnt(12)
    v_mfma_f32_32x32x16_bf16 v[64:79], v[152:155], v[144:147], v[64:79]
    v_mfma_f32_32x32x16_bf16 v[80:95], v[152:155], v[148:151], v[80:95]
    v_mfma_f32_32x32x16_bf16 v[96:111], v[156:159], v[144:147], v[96:111]
    v_mfma_f32_32x32x16_bf16 v[112:127], v[156:159], v[148:151], v[112:127]
    s_waitcnt lgkmcnt(6)
    v_mfma_f32_32x32x16_bf16 v[64:79], v[168:171], v[160:163], v[64:79]
    v_mfma_f32_32x32x16_bf16 v[80:95], v[168:171], v[164:167], v[80:95]
    v_mfma_f32_32x32x16_bf16 v[96:111], v[172:175], v[160:163], v[96:111]
    v_mfma_f32_32x32x16_bf16 v[112:127], v[172:175], v[164:167], v[112:127]
    s_waitcnt lgkmcnt(0)
    v_mfma_f32_32x32x16_bf16 v[64:79], v[136:139], v[128:131], v[64:79]
    v_mfma_f32_32x32x16_bf16 v[80:95], v[136:139], v[132:135], v[80:95]
    v_mfma_f32_32x32x16_bf16 v[96:111], v[140:143], v[128:131], v[96:111]
    v_mfma_f32_32x32x16_bf16 v[112:127], v[140:143], v[132:135], v[112:127]
    s_waitcnt vmcnt(6)
    s_barrier
    s_mov_b32 s47, 896
    s_mov_b32 s48, 458752
    s_add_u32 m0, s51, 49152
    s_nop 0
    buffer_load_dwordx4 v10, s[12:15], s47 offen lds
    s_add_u32 m0, s51, 57344
    s_nop 0
    buffer_load_dwordx4 v11, s[12:15], s47 offen lds
    s_add_u32 m0, s51, 65536
    s_nop 0
    buffer_load_dwordx4 v13, s[16:19], s48 offen lds
    s_add_u32 m0, s51, 73728
    s_nop 0
    buffer_load_dwordx4 v14, s[16:19], s48 offen lds
    s_add_u32 m0, s51, 81920
    s_nop 0
    buffer_load_dwordx4 v15, s[16:19], s48 offen lds
    s_add_u32 m0, s51, 90112
    s_nop 0
    buffer_load_dwordx4 v16, s[16:19], s48 offen lds
    ds_read_b128 v[128:131], v36 offset:0
    ds_read_b128 v[132:135], v36 offset:4096
    ds_read_b64_tr_b16 v[136:137], v40 offset:0
    ds_read_b64_tr_b16 v[138:139], v40 offset:2048
    ds_read_b64_tr_b16 v[140:141], v41 offset:0
    ds_read_b64_tr_b16 v[142:143], v41 offset:2048
    ds_read_b128 v[144:147], v37 offset:0
    ds_read_b128 v[148:151], v37 offset:4096
    ds_read_b64_tr_b16 v[152:153], v40 offset:8192
    ds_read_b64_tr_b16 v[154:155], v40 offset:10240
    ds_read_b64_tr_b16 v[156:157], v41 offset:8192
    ds_read_b64_tr_b16 v[158:159], v41 offset:10240
    ds_read_b128 v[160:163], v38 offset:0
    ds_read_b128 v[164:167], v38 offset:4096
    ds_read_b64_tr_b16 v[168:169], v40 offset:16384
    ds_read_b64_tr_b16 v[170:171], v40 offset:18432
    ds_read_b64_tr_b16 v[172:173], v41 offset:16384
    ds_read_b64_tr_b16 v[174:175], v41 offset:18432
    s_waitcnt lgkmcnt(12)
    v_mfma_f32_32x32x16_bf16 v[64:79], v[136:139], v[128:131], v[64:79]
    v_mfma_f32_32x32x16_bf16 v[80:95], v[136:139], v[132:135], v[80:95]
    v_mfma_f32_32x32x16_bf16 v[96:111], v[140:143], v[128:131], v[96:111]
    v_mfma_f32_32x32x16_bf16 v[112:127], v[140:143], v[132:135], v[112:127]
    ds_read_b128 v[128:131], v39 offset:0
    ds_read_b128 v[132:135], v39 offset:4096
    ds_read_b64_tr_b16 v[136:137], v40 offset:24576
    ds_read_b64_tr_b16 v[138:139], v40 offset:26624
    ds_read_b64_tr_b16 v[140:141], v41 offset:24576
    ds_read_b64_tr_b16 v[142:143], v41 offset:26624
    s_waitcnt lgkmcnt(12)
    v_mfma_f32_32x32x16_bf16 v[64:79], v[152:155], v[144:147], v[64:79]
    v_mfma_f32_32x32x16_bf16 v[80:95], v[152:155], v[148:151], v[80:95]
    v_mfma_f32_32x32x16_bf16 v[96:111], v[156:159], v[144:147], v[96:111]
    v_mfma_f32_32x32x16_bf16 v[112:127], v[156:159], v[148:151], v[112:127]
    s_waitcnt lgkmcnt(6)
    v_mfma_f32_32x32x16_bf16 v[64:79], v[168:171], v[160:163], v[64:79]
    v_mfma_f32_32x32x16_bf16 v[80:95], v[168:171], v[164:167], v[80:95]
    v_mfma_f32_32x32x16_bf16 v[96:111], v[172:175], v[160:163], v[96:111]
    v_mfma_f32_32x32x16_bf16 v[112:127], v[172:175], v[164:167], v[112:127]
    s_waitcnt lgkmcnt(0)
    v_mfma_f32_32x32x16_bf16 v[64:79], v[136:139], v[128:131], v[64:79]
    v_mfma_f32_32x32x16_bf16 v[80:95], v[136:139], v[132:135], v[80:95]
    v_mfma_f32_32x32x16_bf16 v[96:111], v[140:143], v[128:131], v[96:111]
    v_mfma_f32_32x32x16_bf16 v[112:127], v[140:143], v[132:135], v[112:127]
    s_waitcnt vmcnt(6)
    s_barrier
    ds_read_b128 v[128:131], v20 offset:0
    ds_read_b128 v[132:135], v20 offset:4096
    ds_read_b64_tr_b16 v[136:137], v24 offset:0
    ds_read_b64_tr_b16 v[138:139], v24 offset:2048
    ds_read_b64_tr_b16 v[140:141], v25 offset:0
    ds_read_b64_tr_b16 v[142:143], v25 offset:2048
    ds_read_b128 v[144:147], v21 offset:0
    ds_read_b128 v[148:151], v21 offset:4096
    ds_read_b64_tr_b16 v[152:153], v24 offset:8192
    ds_read_b64_tr_b16 v[154:155], v24 offset:10240
    ds_read_b64_tr_b16 v[156:157], v25 offset:8192
    ds_read_b64_tr_b16 v[158:159], v25 offset:10240
    ds_read_b128 v[160:163], v22 offset:0
    ds_read_b128 v[164:167], v22 offset:4096
    ds_read_b64_tr_b16 v[168:169], v24 offset:16384
    ds_read_b64_tr_b16 v[170:171], v24 offset:18432
    ds_read_b64_tr_b16 v[172:173], v25 offset:16384
    ds_read_b64_tr_b16 v[174:175], v25 offset:18432
    s_waitcnt lgkmcnt(12)
    v_mfma_f32_32x32x16_bf16 v[64:79], v[136:139], v[128:131], v[64:79]
    v_mfma_f32_32x32x16_bf16 v[80:95], v[136:139], v[132:135], v[80:95]
    v_mfma_f32_32x32x16_bf16 v[96:111], v[140:143], v[128:131], v[96:111]
    v_mfma_f32_32x32x16_bf16 v[112:127], v[140:143], v[132:135], v[112:127]
    ds_read_b128 v[128:131], v23 offset:0
    ds_read_b128 v[132:135], v23 offset:4096
    ds_read_b64_tr_b16 v[136:137], v24 offset:24576
    ds_read_b64_tr_b16 v[138:139], v24 offset:26624
    ds_read_b64_tr_b16 v[140:141], v25 offset:24576
    ds_read_b64_tr_b16 v[142:143], v25 offset:26624
    s_waitcnt lgkmcnt(12)
    v_mfma_f32_32x32x16_bf16 v[64:79], v[152:155], v[144:147], v[64:79]
    v_mfma_f32_32x32x16_bf16 v[80:95], v[152:155], v[148:151], v[80:95]
    v_mfma_f32_32x32x16_bf16 v[96:111], v[156:159], v[144:147], v[96:111]
    v_mfma_f32_32x32x16_bf16 v[112:127], v[156:159], v[148:151], v[112:127]
    s_waitcnt lgkmcnt(6)
    v_mfma_f32_32x32x16_bf16 v[64:79], v[168:171], v[160:163], v[64:79]
    v_mfma_f32_32x32x16_bf16 v[80:95], v[168:171], v[164:167], v[80:95]
    v_mfma_f32_32x32x16_bf16 v[96:111], v[172:175], v[160:163], v[96:111]
    v_mfma_f32_32x32x16_bf16 v[112:127], v[172:175], v[164:167], v[112:127]
    s_waitcnt lgkmcnt(0)
    v_mfma_f32_32x32x16_bf16 v[64:79], v[136:139], v[128:131], v[64:79]
    v_mfma_f32_32x32x16_bf16 v[80:95], v[136:139], v[132:135], v[80:95]
    v_mfma_f32_32x32x16_bf16 v[96:111], v[140:143], v[128:131], v[96:111]
    v_mfma_f32_32x32x16_bf16 v[112:127], v[140:143], v[132:135], v[112:127]
    s_waitcnt vmcnt(0)
    s_barrier
    ds_read_b128 v[128:131], v28 offset:0
    ds_read_b128 v[132:135], v28 offset:4096
    ds_read_b64_tr_b16 v[136:137], v32 offset:0
    ds_read_b64_tr_b16 v[138:139], v32 offset:2048
    ds_read_b64_tr_b16 v[140:141], v33 offset:0
    ds_read_b64_tr_b16 v[142:143], v33 offset:2048
    ds_read_b128 v[144:147], v29 offset:0
    ds_read_b128 v[148:151], v29 offset:4096
    ds_read_b64_tr_b16 v[152:153], v32 offset:8192
    ds_read_b64_tr_b16 v[154:155], v32 offset:10240
    ds_read_b64_tr_b16 v[156:157], v33 offset:8192
    ds_read_b64_tr_b16 v[158:159], v33 offset:10240
    ds_read_b128 v[160:163], v30 offset:0
    ds_read_b128 v[164:167], v30 offset:4096
    ds_read_b64_tr_b16 v[168:169], v32 offset:16384
    ds_read_b64_tr_b16 v[170:171], v32 offset:18432
    ds_read_b64_tr_b16 v[172:173], v33 offset:16384
    ds_read_b64_tr_b16 v[174:175], v33 offset:18432
    s_waitcnt lgkmcnt(12)
    v_mfma_f32_32x32x16_bf16 v[64:79], v[136:139], v[128:131], v[64:79]
    v_mfma_f32_32x32x16_bf16 v[80:95], v[136:139], v[132:135], v[80:95]
    v_mfma_f32_32x32x16_bf16 v[96:111], v[140:143], v[128:131], v[96:111]
    v_mfma_f32_32x32x16_bf16 v[112:127], v[140:143], v[132:135], v[112:127]
    ds_read_b128 v[128:131], v31 offset:0
    ds_read_b128 v[132:135], v31 offset:4096
    ds_read_b64_tr_b16 v[136:137], v32 offset:24576
    ds_read_b64_tr_b16 v[138:139], v32 offset:26624
    ds_read_b64_tr_b16 v[140:141], v33 offset:24576
    ds_read_b64_tr_b16 v[142:143], v33 offset:26624
    s_waitcnt lgkmcnt(12)
    v_mfma_f32_32x32x16_bf16 v[64:79], v[152:155], v[144:147], v[64:79]
    v_mfma_f32_32x32x16_bf16 v[80:95], v[152:155], v[148:151], v[80:95]
    v_mfma_f32_32x32x16_bf16 v[96:111], v[156:159], v[144:147], v[96:111]
    v_mfma_f32_32x32x16_bf16 v[112:127], v[156:159], v[148:151], v[112:127]
    s_waitcnt lgkmcnt(6)
    v_mfma_f32_32x32x16_bf16 v[64:79], v[168:171], v[160:163], v[64:79]
    v_mfma_f32_32x32x16_bf16 v[80:95], v[168:171], v[164:167], v[80:95]
    v_mfma_f32_32x32x16_bf16 v[96:111], v[172:175], v[160:163], v[96:111]
    v_mfma_f32_32x32x16_bf16 v[112:127], v[172:175], v[164:167], v[112:127]
    s_waitcnt lgkmcnt(0)
    v_mfma_f32_32x32x16_bf16 v[64:79], v[136:139], v[128:131], v[64:79]
    v_mfma_f32_32x32x16_bf16 v[80:95], v[136:139], v[132:135], v[80:95]
    v_mfma_f32_32x32x16_bf16 v[96:111], v[140:143], v[128:131], v[96:111]
    v_mfma_f32_32x32x16_bf16 v[112:127], v[140:143], v[132:135], v[112:127]
    s_nop 7
    s_nop 7
    v_and_b32 v3, 31, v1
    v_and_b32 v4, 1, v2
    v_lshlrev_b32 v4, 6, v4
    v_add_u32 v4, v4, v3
    s_lshl_b32 s44, s40, 7
    v_add_u32 v4, s44, v4
    v_lshrrev_b32 v5, 5, v1
    v_lshlrev_b32 v5, 2, v5
    v_lshrrev_b32 v6, 1, v2
    s_add_u32 s24, s8, 34603008
    s_addc_u32 s25, s9, 0
    s_mov_b32 s26, 33554432
    s_mov_b32 s27, 0x00020000
    v_lshlrev_b32 v6, 6, v6
    v_add_u32 v5, v5, v6
    s_lshl_b32 s46, s42, 8
    v_add_u32 v5, s46, v5
    v_lshlrev_b32 v4, 9, v4
    v_add_u32 v4, v4, v5
    v_lshlrev_b32 v4, 2, v4
    s_mul_i32 s46, s43, 4194304
    v_add_u32 v4, s46, v4
    v_add_u32 v5, 65536, v4
    buffer_store_dwordx4 v[64:67], v4, s[24:27], 0 offen offset:0
    buffer_store_dwordx4 v[68:71], v4, s[24:27], 0 offen offset:32
    buffer_store_dwordx4 v[72:75], v4, s[24:27], 0 offen offset:64
    buffer_store_dwordx4 v[76:79], v4, s[24:27], 0 offen offset:96
    buffer_store_dwordx4 v[80:83], v5, s[24:27], 0 offen offset:0
    buffer_store_dwordx4 v[84:87], v5, s[24:27], 0 offen offset:32
    buffer_store_dwordx4 v[88:91], v5, s[24:27], 0 offen offset:64
    buffer_store_dwordx4 v[92:95], v5, s[24:27], 0 offen offset:96
    buffer_store_dwordx4 v[96:99], v4, s[24:27], 0 offen offset:128
    buffer_store_dwordx4 v[100:103], v4, s[24:27], 0 offen offset:160
    buffer_store_dwordx4 v[104:107], v4, s[24:27], 0 offen offset:192
    buffer_store_dwordx4 v[108:111], v4, s[24:27], 0 offen offset:224
    buffer_store_dwordx4 v[112:115], v5, s[24:27], 0 offen offset:128
    buffer_store_dwordx4 v[116:119], v5, s[24:27], 0 offen offset:160
    buffer_store_dwordx4 v[120:123], v5, s[24:27], 0 offen offset:192
    buffer_store_dwordx4 v[124:127], v5, s[24:27], 0 offen offset:224
wo_kernel_done:
    s_endpgm
.globl ln2_kernel
.p2align 8
.type ln2_kernel,@function
ln2_kernel:
    s_cmp_ge_u32 s2, 512
    s_cbranch_scc1 ln2_kernel_done
    s_load_dwordx2 s[4:5], s[0:1], 0
    s_load_dwordx2 s[8:9], s[0:1], 104
    v_lshrrev_b32 v1, 6, v0
    v_and_b32 v2, 63, v0
    s_lshl_b32 s3, s2, 2
    v_add_u32 v1, s3, v1
    s_waitcnt lgkmcnt(0)
    s_mov_b32 s12, s4
    s_mov_b32 s13, s5
    s_mov_b32 s14, 2097152
    s_mov_b32 s15, 0x00020000
    s_mov_b32 s16, s8
    s_mov_b32 s17, s9
    s_mov_b32 s18, 12288
    s_mov_b32 s19, 0x00020000
    s_add_u32 s20, s8, 70254592
    s_addc_u32 s21, s9, 0
    s_mov_b32 s22, 2097152
    s_mov_b32 s23, 0x00020000
    s_add_u32 s24, s8, 68157440
    s_addc_u32 s25, s9, 0
    s_mov_b32 s26, 2097152
    s_mov_b32 s27, 0x00020000
    s_add_u32 s28, s8, 34603008
    s_addc_u32 s29, s9, 0
    s_mov_b32 s30, 33554432
    s_mov_b32 s31, 0x00020000
    v_xor_b32 v10, 1, v2
    v_lshlrev_b32 v10, 2, v10
    v_xor_b32 v11, 2, v2
    v_lshlrev_b32 v11, 2, v11
    v_xor_b32 v12, 4, v2
    v_lshlrev_b32 v12, 2, v12
    v_xor_b32 v13, 8, v2
    v_lshlrev_b32 v13, 2, v13
    v_xor_b32 v14, 16, v2
    v_lshlrev_b32 v14, 2, v14
    v_xor_b32 v15, 32, v2
    v_lshlrev_b32 v15, 2, v15
    v_lshlrev_b32 v3, 10, v1
    v_lshlrev_b32 v4, 4, v2
    v_add_u32 v3, v3, v4
    v_lshlrev_b32 v5, 1, v3
    v_lshlrev_b32 v6, 5, v2
    buffer_load_dwordx4 v[16:19], v3, s[12:15], 0 offen
    s_mov_b32 s33, 8192
    buffer_load_dwordx4 v[32:35], v6, s[16:19], s33 offen
    buffer_load_dwordx4 v[36:39], v6, s[16:19], s33 offen offset:16
    s_mov_b32 s33, 6144
    buffer_load_dwordx4 v[40:43], v6, s[16:19], s33 offen
    buffer_load_dwordx4 v[44:47], v6, s[16:19], s33 offen offset:16
    s_mov_b32 s33, 4096
    buffer_load_dwordx4 v[48:51], v6, s[16:19], s33 offen
    buffer_load_dwordx4 v[52:55], v6, s[16:19], s33 offen offset:16
    s_mov_b32 s33, 0
    buffer_load_dwordx4 v[64:67], v5, s[28:31], s33 offen
    buffer_load_dwordx4 v[68:71], v5, s[28:31], s33 offen offset:16
    s_mov_b32 s33, 4194304
    buffer_load_dwordx4 v[72:75], v5, s[28:31], s33 offen
    buffer_load_dwordx4 v[76:79], v5, s[28:31], s33 offen offset:16
    s_mov_b32 s33, 8388608
    buffer_load_dwordx4 v[80:83], v5, s[28:31], s33 offen
    buffer_load_dwordx4 v[84:87], v5, s[28:31], s33 offen offset:16
    s_mov_b32 s33, 12582912
    buffer_load_dwordx4 v[88:91], v5, s[28:31], s33 offen
    buffer_load_dwordx4 v[92:95], v5, s[28:31], s33 offen offset:16
    s_mov_b32 s33, 16777216
    buffer_load_dwordx4 v[96:99], v5, s[28:31], s33 offen
    buffer_load_dwordx4 v[100:103], v5, s[28:31], s33 offen offset:16
    s_mov_b32 s33, 20971520
    buffer_load_dwordx4 v[104:107], v5, s[28:31], s33 offen
    buffer_load_dwordx4 v[108:111], v5, s[28:31], s33 offen offset:16
    s_mov_b32 s33, 25165824
    buffer_load_dwordx4 v[112:115], v5, s[28:31], s33 offen
    buffer_load_dwordx4 v[116:119], v5, s[28:31], s33 offen offset:16
    s_mov_b32 s33, 29360128
    buffer_load_dwordx4 v[120:123], v5, s[28:31], s33 offen
    buffer_load_dwordx4 v[124:127], v5, s[28:31], s33 offen offset:16
    s_waitcnt vmcnt(14)
    v_mov_b32 v56, v64
    v_mov_b32 v57, v65
    v_mov_b32 v58, v66
    v_mov_b32 v59, v67
    v_mov_b32 v60, v68
    v_mov_b32 v61, v69
    v_mov_b32 v62, v70
    v_mov_b32 v63, v71
    s_waitcnt vmcnt(12)
    v_add_f32 v56, v56, v72
    v_add_f32 v57, v57, v73
    v_add_f32 v58, v58, v74
    v_add_f32 v59, v59, v75
    v_add_f32 v60, v60, v76
    v_add_f32 v61, v61, v77
    v_add_f32 v62, v62, v78
    v_add_f32 v63, v63, v79
    s_waitcnt vmcnt(10)
    v_add_f32 v56, v56, v80
    v_add_f32 v57, v57, v81
    v_add_f32 v58, v58, v82
    v_add_f32 v59, v59, v83
    v_add_f32 v60, v60, v84
    v_add_f32 v61, v61, v85
    v_add_f32 v62, v62, v86
    v_add_f32 v63, v63, v87
    s_waitcnt vmcnt(8)
    v_add_f32 v56, v56, v88
    v_add_f32 v57, v57, v89
    v_add_f32 v58, v58, v90
    v_add_f32 v59, v59, v91
    v_add_f32 v60, v60, v92
    v_add_f32 v61, v61, v93
    v_add_f32 v62, v62, v94
    v_add_f32 v63, v63, v95
    s_waitcnt vmcnt(6)
    v_add_f32 v56, v56, v96
    v_add_f32 v57, v57, v97
    v_add_f32 v58, v58, v98
    v_add_f32 v59, v59, v99
    v_add_f32 v60, v60, v100
    v_add_f32 v61, v61, v101
    v_add_f32 v62, v62, v102
    v_add_f32 v63, v63, v103
    s_waitcnt vmcnt(4)
    v_add_f32 v56, v56, v104
    v_add_f32 v57, v57, v105
    v_add_f32 v58, v58, v106
    v_add_f32 v59, v59, v107
    v_add_f32 v60, v60, v108
    v_add_f32 v61, v61, v109
    v_add_f32 v62, v62, v110
    v_add_f32 v63, v63, v111
    s_waitcnt vmcnt(2)
    v_add_f32 v56, v56, v112
    v_add_f32 v57, v57, v113
    v_add_f32 v58, v58, v114
    v_add_f32 v59, v59, v115
    v_add_f32 v60, v60, v116
    v_add_f32 v61, v61, v117
    v_add_f32 v62, v62, v118
    v_add_f32 v63, v63, v119
    s_waitcnt vmcnt(0)
    v_add_f32 v56, v56, v120
    v_add_f32 v57, v57, v121
    v_add_f32 v58, v58, v122
    v_add_f32 v59, v59, v123
    v_add_f32 v60, v60, v124
    v_add_f32 v61, v61, v125
    v_add_f32 v62, v62, v126
    v_add_f32 v63, v63, v127
    s_waitcnt vmcnt(0)
    v_lshlrev_b32 v20, 16, v16
    v_and_b32 v21, 0xffff0000, v16
    v_lshlrev_b32 v22, 16, v17
    v_and_b32 v23, 0xffff0000, v17
    v_lshlrev_b32 v24, 16, v18
    v_and_b32 v25, 0xffff0000, v18
    v_lshlrev_b32 v26, 16, v19
    v_and_b32 v27, 0xffff0000, v19
    v_cvt_pk_bf16_f32 v56, v56, v56
    v_lshlrev_b32 v56, 16, v56
    v_mul_f32 v56, v48, v56
    v_cvt_pk_bf16_f32 v56, v56, v56
    v_lshlrev_b32 v56, 16, v56
    v_add_f32 v20, v20, v56
    v_cvt_pk_bf16_f32 v57, v57, v57
    v_lshlrev_b32 v57, 16, v57
    v_mul_f32 v57, v49, v57
    v_cvt_pk_bf16_f32 v57, v57, v57
    v_lshlrev_b32 v57, 16, v57
    v_add_f32 v21, v21, v57
    v_cvt_pk_bf16_f32 v58, v58, v58
    v_lshlrev_b32 v58, 16, v58
    v_mul_f32 v58, v50, v58
    v_cvt_pk_bf16_f32 v58, v58, v58
    v_lshlrev_b32 v58, 16, v58
    v_add_f32 v22, v22, v58
    v_cvt_pk_bf16_f32 v59, v59, v59
    v_lshlrev_b32 v59, 16, v59
    v_mul_f32 v59, v51, v59
    v_cvt_pk_bf16_f32 v59, v59, v59
    v_lshlrev_b32 v59, 16, v59
    v_add_f32 v23, v23, v59
    v_cvt_pk_bf16_f32 v60, v60, v60
    v_lshlrev_b32 v60, 16, v60
    v_mul_f32 v60, v52, v60
    v_cvt_pk_bf16_f32 v60, v60, v60
    v_lshlrev_b32 v60, 16, v60
    v_add_f32 v24, v24, v60
    v_cvt_pk_bf16_f32 v61, v61, v61
    v_lshlrev_b32 v61, 16, v61
    v_mul_f32 v61, v53, v61
    v_cvt_pk_bf16_f32 v61, v61, v61
    v_lshlrev_b32 v61, 16, v61
    v_add_f32 v25, v25, v61
    v_cvt_pk_bf16_f32 v62, v62, v62
    v_lshlrev_b32 v62, 16, v62
    v_mul_f32 v62, v54, v62
    v_cvt_pk_bf16_f32 v62, v62, v62
    v_lshlrev_b32 v62, 16, v62
    v_add_f32 v26, v26, v62
    v_cvt_pk_bf16_f32 v63, v63, v63
    v_lshlrev_b32 v63, 16, v63
    v_mul_f32 v63, v55, v63
    v_cvt_pk_bf16_f32 v63, v63, v63
    v_lshlrev_b32 v63, 16, v63
    v_add_f32 v27, v27, v63
    v_cvt_pk_bf16_f32 v16, v20, v21
    v_cvt_pk_bf16_f32 v17, v22, v23
    v_cvt_pk_bf16_f32 v18, v24, v25
    v_cvt_pk_bf16_f32 v19, v26, v27
    buffer_store_dwordx4 v[16:19], v3, s[24:27], 0 offen
    v_lshlrev_b32 v20, 16, v16
    v_and_b32 v21, 0xffff0000, v16
    v_lshlrev_b32 v22, 16, v17
    v_and_b32 v23, 0xffff0000, v17
    v_lshlrev_b32 v24, 16, v18
    v_and_b32 v25, 0xffff0000, v18
    v_lshlrev_b32 v26, 16, v19
    v_and_b32 v27, 0xffff0000, v19
    v_add_f32 v7, v20, v21
    v_add_f32 v7, v7, v22
    v_add_f32 v7, v7, v23
    v_add_f32 v7, v7, v24
    v_add_f32 v7, v7, v25
    v_add_f32 v7, v7, v26
    v_add_f32 v7, v7, v27
    ds_bpermute_b32 v8, v10, v7
    s_waitcnt lgkmcnt(0)
    v_add_f32 v7, v7, v8
    ds_bpermute_b32 v8, v11, v7
    s_waitcnt lgkmcnt(0)
    v_add_f32 v7, v7, v8
    ds_bpermute_b32 v8, v12, v7
    s_waitcnt lgkmcnt(0)
    v_add_f32 v7, v7, v8
    ds_bpermute_b32 v8, v13, v7
    s_waitcnt lgkmcnt(0)
    v_add_f32 v7, v7, v8
    ds_bpermute_b32 v8, v14, v7
    s_waitcnt lgkmcnt(0)
    v_add_f32 v7, v7, v8
    ds_bpermute_b32 v8, v15, v7
    s_waitcnt lgkmcnt(0)
    v_add_f32 v7, v7, v8
    v_mul_f32 v7, 0x3b000000, v7
    v_mov_b32 v9, 0
    v_sub_f32 v8, v20, v7
    v_fmac_f32 v9, v8, v8
    v_sub_f32 v8, v21, v7
    v_fmac_f32 v9, v8, v8
    v_sub_f32 v8, v22, v7
    v_fmac_f32 v9, v8, v8
    v_sub_f32 v8, v23, v7
    v_fmac_f32 v9, v8, v8
    v_sub_f32 v8, v24, v7
    v_fmac_f32 v9, v8, v8
    v_sub_f32 v8, v25, v7
    v_fmac_f32 v9, v8, v8
    v_sub_f32 v8, v26, v7
    v_fmac_f32 v9, v8, v8
    v_sub_f32 v8, v27, v7
    v_fmac_f32 v9, v8, v8
    ds_bpermute_b32 v8, v10, v9
    s_waitcnt lgkmcnt(0)
    v_add_f32 v9, v9, v8
    ds_bpermute_b32 v8, v11, v9
    s_waitcnt lgkmcnt(0)
    v_add_f32 v9, v9, v8
    ds_bpermute_b32 v8, v12, v9
    s_waitcnt lgkmcnt(0)
    v_add_f32 v9, v9, v8
    ds_bpermute_b32 v8, v13, v9
    s_waitcnt lgkmcnt(0)
    v_add_f32 v9, v9, v8
    ds_bpermute_b32 v8, v14, v9
    s_waitcnt lgkmcnt(0)
    v_add_f32 v9, v9, v8
    ds_bpermute_b32 v8, v15, v9
    s_waitcnt lgkmcnt(0)
    v_add_f32 v9, v9, v8
    v_mul_f32 v9, 0x3b000000, v9
    v_cvt_pk_bf16_f32 v7, v7, v7
    v_lshlrev_b32 v7, 16, v7
    v_cvt_pk_bf16_f32 v9, v9, v9
    v_lshlrev_b32 v9, 16, v9
    v_add_f32 v9, 0x3727c5ac, v9
    v_cvt_pk_bf16_f32 v9, v9, v9
    v_lshlrev_b32 v9, 16, v9
    v_sqrt_f32 v9, v9
    s_nop 0
    v_cvt_pk_bf16_f32 v9, v9, v9
    v_lshlrev_b32 v9, 16, v9
    v_rcp_f32 v8, v9
    s_nop 0
    v_sub_f32 v20, v20, v7
    v_cvt_pk_bf16_f32 v20, v20, v20
    v_lshlrev_b32 v20, 16, v20
    v_mul_f32 v28, v20, v8
    v_fma_f32 v29, -v28, v9, v20
    v_fma_f32 v20, v29, v8, v28
    v_cvt_pk_bf16_f32 v20, v20, v20
    v_lshlrev_b32 v20, 16, v20
    v_add_f32 v32, 1.0, v32
    v_cvt_pk_bf16_f32 v32, v32, v32
    v_lshlrev_b32 v32, 16, v32
    v_mul_f32 v20, v20, v32
    v_cvt_pk_bf16_f32 v20, v20, v20
    v_lshlrev_b32 v20, 16, v20
    v_add_f32 v20, v20, v40
    v_sub_f32 v21, v21, v7
    v_cvt_pk_bf16_f32 v21, v21, v21
    v_lshlrev_b32 v21, 16, v21
    v_mul_f32 v28, v21, v8
    v_fma_f32 v29, -v28, v9, v21
    v_fma_f32 v21, v29, v8, v28
    v_cvt_pk_bf16_f32 v21, v21, v21
    v_lshlrev_b32 v21, 16, v21
    v_add_f32 v33, 1.0, v33
    v_cvt_pk_bf16_f32 v33, v33, v33
    v_lshlrev_b32 v33, 16, v33
    v_mul_f32 v21, v21, v33
    v_cvt_pk_bf16_f32 v21, v21, v21
    v_lshlrev_b32 v21, 16, v21
    v_add_f32 v21, v21, v41
    v_sub_f32 v22, v22, v7
    v_cvt_pk_bf16_f32 v22, v22, v22
    v_lshlrev_b32 v22, 16, v22
    v_mul_f32 v28, v22, v8
    v_fma_f32 v29, -v28, v9, v22
    v_fma_f32 v22, v29, v8, v28
    v_cvt_pk_bf16_f32 v22, v22, v22
    v_lshlrev_b32 v22, 16, v22
    v_add_f32 v34, 1.0, v34
    v_cvt_pk_bf16_f32 v34, v34, v34
    v_lshlrev_b32 v34, 16, v34
    v_mul_f32 v22, v22, v34
    v_cvt_pk_bf16_f32 v22, v22, v22
    v_lshlrev_b32 v22, 16, v22
    v_add_f32 v22, v22, v42
    v_sub_f32 v23, v23, v7
    v_cvt_pk_bf16_f32 v23, v23, v23
    v_lshlrev_b32 v23, 16, v23
    v_mul_f32 v28, v23, v8
    v_fma_f32 v29, -v28, v9, v23
    v_fma_f32 v23, v29, v8, v28
    v_cvt_pk_bf16_f32 v23, v23, v23
    v_lshlrev_b32 v23, 16, v23
    v_add_f32 v35, 1.0, v35
    v_cvt_pk_bf16_f32 v35, v35, v35
    v_lshlrev_b32 v35, 16, v35
    v_mul_f32 v23, v23, v35
    v_cvt_pk_bf16_f32 v23, v23, v23
    v_lshlrev_b32 v23, 16, v23
    v_add_f32 v23, v23, v43
    v_sub_f32 v24, v24, v7
    v_cvt_pk_bf16_f32 v24, v24, v24
    v_lshlrev_b32 v24, 16, v24
    v_mul_f32 v28, v24, v8
    v_fma_f32 v29, -v28, v9, v24
    v_fma_f32 v24, v29, v8, v28
    v_cvt_pk_bf16_f32 v24, v24, v24
    v_lshlrev_b32 v24, 16, v24
    v_add_f32 v36, 1.0, v36
    v_cvt_pk_bf16_f32 v36, v36, v36
    v_lshlrev_b32 v36, 16, v36
    v_mul_f32 v24, v24, v36
    v_cvt_pk_bf16_f32 v24, v24, v24
    v_lshlrev_b32 v24, 16, v24
    v_add_f32 v24, v24, v44
    v_sub_f32 v25, v25, v7
    v_cvt_pk_bf16_f32 v25, v25, v25
    v_lshlrev_b32 v25, 16, v25
    v_mul_f32 v28, v25, v8
    v_fma_f32 v29, -v28, v9, v25
    v_fma_f32 v25, v29, v8, v28
    v_cvt_pk_bf16_f32 v25, v25, v25
    v_lshlrev_b32 v25, 16, v25
    v_add_f32 v37, 1.0, v37
    v_cvt_pk_bf16_f32 v37, v37, v37
    v_lshlrev_b32 v37, 16, v37
    v_mul_f32 v25, v25, v37
    v_cvt_pk_bf16_f32 v25, v25, v25
    v_lshlrev_b32 v25, 16, v25
    v_add_f32 v25, v25, v45
    v_sub_f32 v26, v26, v7
    v_cvt_pk_bf16_f32 v26, v26, v26
    v_lshlrev_b32 v26, 16, v26
    v_mul_f32 v28, v26, v8
    v_fma_f32 v29, -v28, v9, v26
    v_fma_f32 v26, v29, v8, v28
    v_cvt_pk_bf16_f32 v26, v26, v26
    v_lshlrev_b32 v26, 16, v26
    v_add_f32 v38, 1.0, v38
    v_cvt_pk_bf16_f32 v38, v38, v38
    v_lshlrev_b32 v38, 16, v38
    v_mul_f32 v26, v26, v38
    v_cvt_pk_bf16_f32 v26, v26, v26
    v_lshlrev_b32 v26, 16, v26
    v_add_f32 v26, v26, v46
    v_sub_f32 v27, v27, v7
    v_cvt_pk_bf16_f32 v27, v27, v27
    v_lshlrev_b32 v27, 16, v27
    v_mul_f32 v28, v27, v8
    v_fma_f32 v29, -v28, v9, v27
    v_fma_f32 v27, v29, v8, v28
    v_cvt_pk_bf16_f32 v27, v27, v27
    v_lshlrev_b32 v27, 16, v27
    v_add_f32 v39, 1.0, v39
    v_cvt_pk_bf16_f32 v39, v39, v39
    v_lshlrev_b32 v39, 16, v39
    v_mul_f32 v27, v27, v39
    v_cvt_pk_bf16_f32 v27, v27, v27
    v_lshlrev_b32 v27, 16, v27
    v_add_f32 v27, v27, v47
    v_cvt_pk_bf16_f32 v16, v20, v21
    v_cvt_pk_bf16_f32 v17, v22, v23
    v_cvt_pk_bf16_f32 v18, v24, v25
    v_cvt_pk_bf16_f32 v19, v26, v27
    buffer_store_dwordx4 v[16:19], v3, s[20:23], 0 offen
ln2_kernel_done:
    s_endpgm
.globl gateup_kernel
.p2align 8
.type gateup_kernel,@function
gateup_kernel:
    s_cmp_ge_u32 s2, 224
    s_cbranch_scc1 gateup_kernel_done
    s_load_dwordx2 s[4:5], s[0:1], 48
    s_load_dwordx2 s[6:7], s[0:1], 56
    s_load_dwordx2 s[8:9], s[0:1], 104
    s_and_b32 s40, s2, 15
    s_lshr_b32 s41, s2, 4
    s_mov_b32 s42, s41
    s_mov_b32 s43, 0
    v_and_b32 v1, 63, v0
    v_lshrrev_b32 v2, 6, v0
    s_nop 0
    v_readfirstlane_b32 s50, v2
    s_waitcnt lgkmcnt(0)
    s_add_u32 s12, s8, 70254592
    s_addc_u32 s13, s9, 0
    s_mov_b32 s14, 2097152
    s_mov_b32 s15, 0x00020000
    s_mov_b32 s16, s4
    s_mov_b32 s17, s5
    s_mov_b32 s18, 1835008
    s_mov_b32 s19, 0x00020000
    s_mov_b32 s20, s6
    s_mov_b32 s21, s7
    s_mov_b32 s22, 1835008
    s_mov_b32 s23, 0x00020000
    v_lshrrev_b32 v3, 3, v1
    v_lshlrev_b32 v4, 3, v2
    v_add_u32 v3, v3, v4
    v_lshrrev_b32 v5, 1, v3
    v_and_b32 v5, 7, v5
    v_and_b32 v4, 7, v1
    v_xor_b32 v4, v4, v5
    s_lshl_b32 s44, s40, 7
    v_add_u32 v5, s44, v3
    s_mov_b32 s45, 1024
    v_mul_lo_u32 v5, v5, s45
    v_lshlrev_b32 v6, 4, v4
    v_add_u32 v5, v5, v6
    s_mul_i32 s46, s43, 1024
    v_add_u32 v10, s46, v5
    v_add_u32 v11, 65536, v10
    s_lshl_b32 s51, s50, 10
    v_lshrrev_b32 v3, 4, v1
    v_lshlrev_b32 v4, 2, v2
    v_add_u32 v3, v3, v4
    v_and_b32 v5, 3, v3
    v_lshlrev_b32 v5, 2, v5
    v_and_b32 v4, 15, v1
    v_xor_b32 v4, v4, v5
    s_mul_i32 s46, s43, 512
    v_add_u32 v5, s46, v3
    s_mov_b32 s45, 3584
    v_mul_lo_u32 v5, v5, s45
    v_lshlrev_b32 v6, 4, v4
    v_add_u32 v5, v5, v6
    s_lshl_b32 s46, s42, 8
    v_add_u32 v13, s46, v5
    v_add_u32 v14, 114688, v13
    v_mov_b32 v15, v13
    v_mov_b32 v16, v14
    v_and_b32 v3, 31, v1
    v_and_b32 v4, 1, v2
    v_lshlrev_b32 v4, 6, v4
    v_add_u32 v4, v4, v3
    v_lshrrev_b32 v5, 1, v4
    v_and_b32 v5, 7, v5
    v_lshrrev_b32 v6, 5, v1
    v_lshlrev_b32 v7, 7, v4
    v_add_u32 v8, 0, v6
    v_xor_b32 v8, v8, v5
    v_lshlrev_b32 v8, 4, v8
    v_add_u32 v20, v7, v8
    v_add_u32 v8, 2, v6
    v_xor_b32 v8, v8, v5
    v_lshlrev_b32 v8, 4, v8
    v_add_u32 v21, v7, v8
    v_add_u32 v8, 4, v6
    v_xor_b32 v8, v8, v5
    v_lshlrev_b32 v8, 4, v8
    v_add_u32 v22, v7, v8
    v_add_u32 v8, 6, v6
    v_xor_b32 v8, v8, v5
    v_lshlrev_b32 v8, 4, v8
    v_add_u32 v23, v7, v8
    v_lshrrev_b32 v3, 4, v1
    v_and_b32 v4, 15, v1
    v_lshrrev_b32 v5, 1, v2
    v_lshlrev_b32 v5, 2, v5
    v_and_b32 v6, 1, v3
    v_lshlrev_b32 v6, 1, v6
    v_add_u32 v5, v5, v6
    v_and_b32 v6, 3, v4
    v_lshrrev_b32 v6, 1, v6
    v_add_u32 v5, v5, v6
    v_lshrrev_b32 v6, 2, v4
    v_lshrrev_b32 v7, 1, v3
    v_lshlrev_b32 v7, 3, v7
    v_add_u32 v7, v7, v6
    v_lshlrev_b32 v7, 8, v7
    v_and_b32 v8, 1, v4
    v_lshlrev_b32 v8, 3, v8
    v_add_u32 v7, v7, v8
    v_lshlrev_b32 v6, 2, v6
    v_mov_b32 v8, v5
    v_xor_b32 v8, v8, v6
    v_lshlrev_b32 v8, 4, v8
    v_add_u32 v8, v8, v7
    v_add_u32 v24, 16384, v8
    v_mov_b32 v8, v5
    v_xor_b32 v8, v8, v6
    v_lshlrev_b32 v8, 4, v8
    v_add_u32 v8, v8, v7
    v_add_u32 v25, 32768, v8
    v_add_u32 v28, 49152, v20
    v_add_u32 v29, 49152, v21
    v_add_u32 v30, 49152, v22
    v_add_u32 v31, 49152, v23
    v_add_u32 v32, 49152, v24
    v_add_u32 v33, 49152, v25
    v_add_u32 v36, 98304, v20
    v_add_u32 v37, 98304, v21
    v_add_u32 v38, 98304, v22
    v_add_u32 v39, 98304, v23
    v_add_u32 v40, 98304, v24
    v_add_u32 v41, 98304, v25
    v_mov_b32 v64, 0
    v_mov_b32 v65, 0
    v_mov_b32 v66, 0
    v_mov_b32 v67, 0
    v_mov_b32 v68, 0
    v_mov_b32 v69, 0
    v_mov_b32 v70, 0
    v_mov_b32 v71, 0
    v_mov_b32 v72, 0
    v_mov_b32 v73, 0
    v_mov_b32 v74, 0
    v_mov_b32 v75, 0
    v_mov_b32 v76, 0
    v_mov_b32 v77, 0
    v_mov_b32 v78, 0
    v_mov_b32 v79, 0
    v_mov_b32 v80, 0
    v_mov_b32 v81, 0
    v_mov_b32 v82, 0
    v_mov_b32 v83, 0
    v_mov_b32 v84, 0
    v_mov_b32 v85, 0
    v_mov_b32 v86, 0
    v_mov_b32 v87, 0
    v_mov_b32 v88, 0
    v_mov_b32 v89, 0
    v_mov_b32 v90, 0
    v_mov_b32 v91, 0
    v_mov_b32 v92, 0
    v_mov_b32 v93, 0
    v_mov_b32 v94, 0
    v_mov_b32 v95, 0
    v_mov_b32 v96, 0
    v_mov_b32 v97, 0
    v_mov_b32 v98, 0
    v_mov_b32 v99, 0
    v_mov_b32 v100, 0
    v_mov_b32 v101, 0
    v_mov_b32 v102, 0
    v_mov_b32 v103, 0
    v_mov_b32 v104, 0
    v_mov_b32 v105, 0
    v_mov_b32 v106, 0
    v_mov_b32 v107, 0
    v_mov_b32 v108, 0
    v_mov_b32 v109, 0
    v_mov_b32 v110, 0
    v_mov_b32 v111, 0
    v_mov_b32 v112, 0
    v_mov_b32 v113, 0
    v_mov_b32 v114, 0
    v_mov_b32 v115, 0
    v_mov_b32 v116, 0
    v_mov_b32 v117, 0
    v_mov_b32 v118, 0
    v_mov_b32 v119, 0
    v_mov_b32 v120, 0
    v_mov_b32 v121, 0
    v_mov_b32 v122, 0
    v_mov_b32 v123, 0
    v_mov_b32 v124, 0
    v_mov_b32 v125, 0
    v_mov_b32 v126, 0
    v_mov_b32 v127, 0
    s_mov_b32 s47, 0
    s_mov_b32 s48, 0
    s_add_u32 m0, s51, 0
    s_nop 0
    buffer_load_dwordx4 v10, s[12:15], s47 offen lds
    s_add_u32 m0, s51, 8192
    s_nop 0
    buffer_load_dwordx4 v11, s[12:15], s47 offen lds
    s_add_u32 m0, s51, 16384
    s_nop 0
    buffer_load_dwordx4 v13, s[16:19], s48 offen lds
    s_add_u32 m0, s51, 24576
    s_nop 0
    buffer_load_dwordx4 v14, s[16:19], s48 offen lds
    s_add_u32 m0, s51, 32768
    s_nop 0
    buffer_load_dwordx4 v15, s[20:23], s48 offen lds
    s_add_u32 m0, s51, 40960
    s_nop 0
    buffer_load_dwordx4 v16, s[20:23], s48 offen lds
    s_mov_b32 s47, 128
    s_mov_b32 s48, 229376
    s_add_u32 m0, s51, 49152
    s_nop 0
    buffer_load_dwordx4 v10, s[12:15], s47 offen lds
    s_add_u32 m0, s51, 57344
    s_nop 0
    buffer_load_dwordx4 v11, s[12:15], s47 offen lds
    s_add_u32 m0, s51, 65536
    s_nop 0
    buffer_load_dwordx4 v13, s[16:19], s48 offen lds
    s_add_u32 m0, s51, 73728
    s_nop 0
    buffer_load_dwordx4 v14, s[16:19], s48 offen lds
    s_add_u32 m0, s51, 81920
    s_nop 0
    buffer_load_dwordx4 v15, s[20:23], s48 offen lds
    s_add_u32 m0, s51, 90112
    s_nop 0
    buffer_load_dwordx4 v16, s[20:23], s48 offen lds
    s_waitcnt vmcnt(6)
    s_barrier
    s_mov_b32 s47, 256
    s_mov_b32 s48, 458752
    s_add_u32 m0, s51, 98304
    s_nop 0
    buffer_load_dwordx4 v10, s[12:15], s47 offen lds
    s_add_u32 m0, s51, 106496
    s_nop 0
    buffer_load_dwordx4 v11, s[12:15], s47 offen lds
    s_add_u32 m0, s51, 114688
    s_nop 0
    buffer_load_dwordx4 v13, s[16:19], s48 offen lds
    s_add_u32 m0, s51, 122880
    s_nop 0
    buffer_load_dwordx4 v14, s[16:19], s48 offen lds
    s_add_u32 m0, s51, 131072
    s_nop 0
    buffer_load_dwordx4 v15, s[20:23], s48 offen lds
    s_add_u32 m0, s51, 139264
    s_nop 0
    buffer_load_dwordx4 v16, s[20:23], s48 offen lds
    ds_read_b128 v[128:131], v20 offset:0
    ds_read_b128 v[132:135], v20 offset:4096
    ds_read_b64_tr_b16 v[136:137], v24 offset:0
    ds_read_b64_tr_b16 v[138:139], v24 offset:1024
    ds_read_b64_tr_b16 v[140:141], v25 offset:0
    ds_read_b64_tr_b16 v[142:143], v25 offset:1024
    ds_read_b128 v[144:147], v21 offset:0
    ds_read_b128 v[148:151], v21 offset:4096
    ds_read_b64_tr_b16 v[152:153], v24 offset:4096
    ds_read_b64_tr_b16 v[154:155], v24 offset:5120
    ds_read_b64_tr_b16 v[156:157], v25 offset:4096
    ds_read_b64_tr_b16 v[158:159], v25 offset:5120
    ds_read_b128 v[160:163], v22 offset:0
    ds_read_b128 v[164:167], v22 offset:4096
    ds_read_b64_tr_b16 v[168:169], v24 offset:8192
    ds_read_b64_tr_b16 v[170:171], v24 offset:9216
    ds_read_b64_tr_b16 v[172:173], v25 offset:8192
    ds_read_b64_tr_b16 v[174:175], v25 offset:9216
    s_waitcnt lgkmcnt(12)
    v_mfma_f32_32x32x16_bf16 v[64:79], v[136:139], v[128:131], v[64:79]
    v_mfma_f32_32x32x16_bf16 v[80:95], v[136:139], v[132:135], v[80:95]
    v_mfma_f32_32x32x16_bf16 v[96:111], v[140:143], v[128:131], v[96:111]
    v_mfma_f32_32x32x16_bf16 v[112:127], v[140:143], v[132:135], v[112:127]
    ds_read_b128 v[128:131], v23 offset:0
    ds_read_b128 v[132:135], v23 offset:4096
    ds_read_b64_tr_b16 v[136:137], v24 offset:12288
    ds_read_b64_tr_b16 v[138:139], v24 offset:13312
    ds_read_b64_tr_b16 v[140:141], v25 offset:12288
    ds_read_b64_tr_b16 v[142:143], v25 offset:13312
    s_waitcnt lgkmcnt(12)
    v_mfma_f32_32x32x16_bf16 v[64:79], v[152:155], v[144:147], v[64:79]
    v_mfma_f32_32x32x16_bf16 v[80:95], v[152:155], v[148:151], v[80:95]
    v_mfma_f32_32x32x16_bf16 v[96:111], v[156:159], v[144:147], v[96:111]
    v_mfma_f32_32x32x16_bf16 v[112:127], v[156:159], v[148:151], v[112:127]
    s_waitcnt lgkmcnt(6)
    v_mfma_f32_32x32x16_bf16 v[64:79], v[168:171], v[160:163], v[64:79]
    v_mfma_f32_32x32x16_bf16 v[80:95], v[168:171], v[164:167], v[80:95]
    v_mfma_f32_32x32x16_bf16 v[96:111], v[172:175], v[160:163], v[96:111]
    v_mfma_f32_32x32x16_bf16 v[112:127], v[172:175], v[164:167], v[112:127]
    s_waitcnt lgkmcnt(0)
    v_mfma_f32_32x32x16_bf16 v[64:79], v[136:139], v[128:131], v[64:79]
    v_mfma_f32_32x32x16_bf16 v[80:95], v[136:139], v[132:135], v[80:95]
    v_mfma_f32_32x32x16_bf16 v[96:111], v[140:143], v[128:131], v[96:111]
    v_mfma_f32_32x32x16_bf16 v[112:127], v[140:143], v[132:135], v[112:127]
    s_waitcnt vmcnt(6)
    s_barrier
    s_mov_b32 s47, 384
    s_mov_b32 s48, 688128
    s_add_u32 m0, s51, 0
    s_nop 0
    buffer_load_dwordx4 v10, s[12:15], s47 offen lds
    s_add_u32 m0, s51, 8192
    s_nop 0
    buffer_load_dwordx4 v11, s[12:15], s47 offen lds
    s_add_u32 m0, s51, 16384
    s_nop 0
    buffer_load_dwordx4 v13, s[16:19], s48 offen lds
    s_add_u32 m0, s51, 24576
    s_nop 0
    buffer_load_dwordx4 v14, s[16:19], s48 offen lds
    s_add_u32 m0, s51, 32768
    s_nop 0
    buffer_load_dwordx4 v15, s[20:23], s48 offen lds
    s_add_u32 m0, s51, 40960
    s_nop 0
    buffer_load_dwordx4 v16, s[20:23], s48 offen lds
    ds_read_b128 v[128:131], v28 offset:0
    ds_read_b128 v[132:135], v28 offset:4096
    ds_read_b64_tr_b16 v[136:137], v32 offset:0
    ds_read_b64_tr_b16 v[138:139], v32 offset:1024
    ds_read_b64_tr_b16 v[140:141], v33 offset:0
    ds_read_b64_tr_b16 v[142:143], v33 offset:1024
    ds_read_b128 v[144:147], v29 offset:0
    ds_read_b128 v[148:151], v29 offset:4096
    ds_read_b64_tr_b16 v[152:153], v32 offset:4096
    ds_read_b64_tr_b16 v[154:155], v32 offset:5120
    ds_read_b64_tr_b16 v[156:157], v33 offset:4096
    ds_read_b64_tr_b16 v[158:159], v33 offset:5120
    ds_read_b128 v[160:163], v30 offset:0
    ds_read_b128 v[164:167], v30 offset:4096
    ds_read_b64_tr_b16 v[168:169], v32 offset:8192
    ds_read_b64_tr_b16 v[170:171], v32 offset:9216
    ds_read_b64_tr_b16 v[172:173], v33 offset:8192
    ds_read_b64_tr_b16 v[174:175], v33 offset:9216
    s_waitcnt lgkmcnt(12)
    v_mfma_f32_32x32x16_bf16 v[64:79], v[136:139], v[128:131], v[64:79]
    v_mfma_f32_32x32x16_bf16 v[80:95], v[136:139], v[132:135], v[80:95]
    v_mfma_f32_32x32x16_bf16 v[96:111], v[140:143], v[128:131], v[96:111]
    v_mfma_f32_32x32x16_bf16 v[112:127], v[140:143], v[132:135], v[112:127]
    ds_read_b128 v[128:131], v31 offset:0
    ds_read_b128 v[132:135], v31 offset:4096
    ds_read_b64_tr_b16 v[136:137], v32 offset:12288
    ds_read_b64_tr_b16 v[138:139], v32 offset:13312
    ds_read_b64_tr_b16 v[140:141], v33 offset:12288
    ds_read_b64_tr_b16 v[142:143], v33 offset:13312
    s_waitcnt lgkmcnt(12)
    v_mfma_f32_32x32x16_bf16 v[64:79], v[152:155], v[144:147], v[64:79]
    v_mfma_f32_32x32x16_bf16 v[80:95], v[152:155], v[148:151], v[80:95]
    v_mfma_f32_32x32x16_bf16 v[96:111], v[156:159], v[144:147], v[96:111]
    v_mfma_f32_32x32x16_bf16 v[112:127], v[156:159], v[148:151], v[112:127]
    s_waitcnt lgkmcnt(6)
    v_mfma_f32_32x32x16_bf16 v[64:79], v[168:171], v[160:163], v[64:79]
    v_mfma_f32_32x32x16_bf16 v[80:95], v[168:171], v[164:167], v[80:95]
    v_mfma_f32_32x32x16_bf16 v[96:111], v[172:175], v[160:163], v[96:111]
    v_mfma_f32_32x32x16_bf16 v[112:127], v[172:175], v[164:167], v[112:127]
    s_waitcnt lgkmcnt(0)
    v_mfma_f32_32x32x16_bf16 v[64:79], v[136:139], v[128:131], v[64:79]
    v_mfma_f32_32x32x16_bf16 v[80:95], v[136:139], v[132:135], v[80:95]
    v_mfma_f32_32x32x16_bf16 v[96:111], v[140:143], v[128:131], v[96:111]
    v_mfma_f32_32x32x16_bf16 v[112:127], v[140:143], v[132:135], v[112:127]
    s_waitcnt vmcnt(6)
    s_barrier
    s_mov_b32 s47, 512
    s_mov_b32 s48, 917504
    s_add_u32 m0, s51, 49152
    s_nop 0
    buffer_load_dwordx4 v10, s[12:15], s47 offen lds
    s_add_u32 m0, s51, 57344
    s_nop 0
    buffer_load_dwordx4 v11, s[12:15], s47 offen lds
    s_add_u32 m0, s51, 65536
    s_nop 0
    buffer_load_dwordx4 v13, s[16:19], s48 offen lds
    s_add_u32 m0, s51, 73728
    s_nop 0
    buffer_load_dwordx4 v14, s[16:19], s48 offen lds
    s_add_u32 m0, s51, 81920
    s_nop 0
    buffer_load_dwordx4 v15, s[20:23], s48 offen lds
    s_add_u32 m0, s51, 90112
    s_nop 0
    buffer_load_dwordx4 v16, s[20:23], s48 offen lds
    ds_read_b128 v[128:131], v36 offset:0
    ds_read_b128 v[132:135], v36 offset:4096
    ds_read_b64_tr_b16 v[136:137], v40 offset:0
    ds_read_b64_tr_b16 v[138:139], v40 offset:1024
    ds_read_b64_tr_b16 v[140:141], v41 offset:0
    ds_read_b64_tr_b16 v[142:143], v41 offset:1024
    ds_read_b128 v[144:147], v37 offset:0
    ds_read_b128 v[148:151], v37 offset:4096
    ds_read_b64_tr_b16 v[152:153], v40 offset:4096
    ds_read_b64_tr_b16 v[154:155], v40 offset:5120
    ds_read_b64_tr_b16 v[156:157], v41 offset:4096
    ds_read_b64_tr_b16 v[158:159], v41 offset:5120
    ds_read_b128 v[160:163], v38 offset:0
    ds_read_b128 v[164:167], v38 offset:4096
    ds_read_b64_tr_b16 v[168:169], v40 offset:8192
    ds_read_b64_tr_b16 v[170:171], v40 offset:9216
    ds_read_b64_tr_b16 v[172:173], v41 offset:8192
    ds_read_b64_tr_b16 v[174:175], v41 offset:9216
    s_waitcnt lgkmcnt(12)
    v_mfma_f32_32x32x16_bf16 v[64:79], v[136:139], v[128:131], v[64:79]
    v_mfma_f32_32x32x16_bf16 v[80:95], v[136:139], v[132:135], v[80:95]
    v_mfma_f32_32x32x16_bf16 v[96:111], v[140:143], v[128:131], v[96:111]
    v_mfma_f32_32x32x16_bf16 v[112:127], v[140:143], v[132:135], v[112:127]
    ds_read_b128 v[128:131], v39 offset:0
    ds_read_b128 v[132:135], v39 offset:4096
    ds_read_b64_tr_b16 v[136:137], v40 offset:12288
    ds_read_b64_tr_b16 v[138:139], v40 offset:13312
    ds_read_b64_tr_b16 v[140:141], v41 offset:12288
    ds_read_b64_tr_b16 v[142:143], v41 offset:13312
    s_waitcnt lgkmcnt(12)
    v_mfma_f32_32x32x16_bf16 v[64:79], v[152:155], v[144:147], v[64:79]
    v_mfma_f32_32x32x16_bf16 v[80:95], v[152:155], v[148:151], v[80:95]
    v_mfma_f32_32x32x16_bf16 v[96:111], v[156:159], v[144:147], v[96:111]
    v_mfma_f32_32x32x16_bf16 v[112:127], v[156:159], v[148:151], v[112:127]
    s_waitcnt lgkmcnt(6)
    v_mfma_f32_32x32x16_bf16 v[64:79], v[168:171], v[160:163], v[64:79]
    v_mfma_f32_32x32x16_bf16 v[80:95], v[168:171], v[164:167], v[80:95]
    v_mfma_f32_32x32x16_bf16 v[96:111], v[172:175], v[160:163], v[96:111]
    v_mfma_f32_32x32x16_bf16 v[112:127], v[172:175], v[164:167], v[112:127]
    s_waitcnt lgkmcnt(0)
    v_mfma_f32_32x32x16_bf16 v[64:79], v[136:139], v[128:131], v[64:79]
    v_mfma_f32_32x32x16_bf16 v[80:95], v[136:139], v[132:135], v[80:95]
    v_mfma_f32_32x32x16_bf16 v[96:111], v[140:143], v[128:131], v[96:111]
    v_mfma_f32_32x32x16_bf16 v[112:127], v[140:143], v[132:135], v[112:127]
    s_waitcnt vmcnt(6)
    s_barrier
    s_mov_b32 s47, 640
    s_mov_b32 s48, 1146880
    s_add_u32 m0, s51, 98304
    s_nop 0
    buffer_load_dwordx4 v10, s[12:15], s47 offen lds
    s_add_u32 m0, s51, 106496
    s_nop 0
    buffer_load_dwordx4 v11, s[12:15], s47 offen lds
    s_add_u32 m0, s51, 114688
    s_nop 0
    buffer_load_dwordx4 v13, s[16:19], s48 offen lds
    s_add_u32 m0, s51, 122880
    s_nop 0
    buffer_load_dwordx4 v14, s[16:19], s48 offen lds
    s_add_u32 m0, s51, 131072
    s_nop 0
    buffer_load_dwordx4 v15, s[20:23], s48 offen lds
    s_add_u32 m0, s51, 139264
    s_nop 0
    buffer_load_dwordx4 v16, s[20:23], s48 offen lds
    ds_read_b128 v[128:131], v20 offset:0
    ds_read_b128 v[132:135], v20 offset:4096
    ds_read_b64_tr_b16 v[136:137], v24 offset:0
    ds_read_b64_tr_b16 v[138:139], v24 offset:1024
    ds_read_b64_tr_b16 v[140:141], v25 offset:0
    ds_read_b64_tr_b16 v[142:143], v25 offset:1024
    ds_read_b128 v[144:147], v21 offset:0
    ds_read_b128 v[148:151], v21 offset:4096
    ds_read_b64_tr_b16 v[152:153], v24 offset:4096
    ds_read_b64_tr_b16 v[154:155], v24 offset:5120
    ds_read_b64_tr_b16 v[156:157], v25 offset:4096
    ds_read_b64_tr_b16 v[158:159], v25 offset:5120
    ds_read_b128 v[160:163], v22 offset:0
    ds_read_b128 v[164:167], v22 offset:4096
    ds_read_b64_tr_b16 v[168:169], v24 offset:8192
    ds_read_b64_tr_b16 v[170:171], v24 offset:9216
    ds_read_b64_tr_b16 v[172:173], v25 offset:8192
    ds_read_b64_tr_b16 v[174:175], v25 offset:9216
    s_waitcnt lgkmcnt(12)
    v_mfma_f32_32x32x16_bf16 v[64:79], v[136:139], v[128:131], v[64:79]
    v_mfma_f32_32x32x16_bf16 v[80:95], v[136:139], v[132:135], v[80:95]
    v_mfma_f32_32x32x16_bf16 v[96:111], v[140:143], v[128:131], v[96:111]
    v_mfma_f32_32x32x16_bf16 v[112:127], v[140:143], v[132:135], v[112:127]
    ds_read_b128 v[128:131], v23 offset:0
    ds_read_b128 v[132:135], v23 offset:4096
    ds_read_b64_tr_b16 v[136:137], v24 offset:12288
    ds_read_b64_tr_b16 v[138:139], v24 offset:13312
    ds_read_b64_tr_b16 v[140:141], v25 offset:12288
    ds_read_b64_tr_b16 v[142:143], v25 offset:13312
    s_waitcnt lgkmcnt(12)
    v_mfma_f32_32x32x16_bf16 v[64:79], v[152:155], v[144:147], v[64:79]
    v_mfma_f32_32x32x16_bf16 v[80:95], v[152:155], v[148:151], v[80:95]
    v_mfma_f32_32x32x16_bf16 v[96:111], v[156:159], v[144:147], v[96:111]
    v_mfma_f32_32x32x16_bf16 v[112:127], v[156:159], v[148:151], v[112:127]
    s_waitcnt lgkmcnt(6)
    v_mfma_f32_32x32x16_bf16 v[64:79], v[168:171], v[160:163], v[64:79]
    v_mfma_f32_32x32x16_bf16 v[80:95], v[168:171], v[164:167], v[80:95]
    v_mfma_f32_32x32x16_bf16 v[96:111], v[172:175], v[160:163], v[96:111]
    v_mfma_f32_32x32x16_bf16 v[112:127], v[172:175], v[164:167], v[112:127]
    s_waitcnt lgkmcnt(0)
    v_mfma_f32_32x32x16_bf16 v[64:79], v[136:139], v[128:131], v[64:79]
    v_mfma_f32_32x32x16_bf16 v[80:95], v[136:139], v[132:135], v[80:95]
    v_mfma_f32_32x32x16_bf16 v[96:111], v[140:143], v[128:131], v[96:111]
    v_mfma_f32_32x32x16_bf16 v[112:127], v[140:143], v[132:135], v[112:127]
    s_waitcnt vmcnt(6)
    s_barrier
    s_mov_b32 s47, 768
    s_mov_b32 s48, 1376256
    s_add_u32 m0, s51, 0
    s_nop 0
    buffer_load_dwordx4 v10, s[12:15], s47 offen lds
    s_add_u32 m0, s51, 8192
    s_nop 0
    buffer_load_dwordx4 v11, s[12:15], s47 offen lds
    s_add_u32 m0, s51, 16384
    s_nop 0
    buffer_load_dwordx4 v13, s[16:19], s48 offen lds
    s_add_u32 m0, s51, 24576
    s_nop 0
    buffer_load_dwordx4 v14, s[16:19], s48 offen lds
    s_add_u32 m0, s51, 32768
    s_nop 0
    buffer_load_dwordx4 v15, s[20:23], s48 offen lds
    s_add_u32 m0, s51, 40960
    s_nop 0
    buffer_load_dwordx4 v16, s[20:23], s48 offen lds
    ds_read_b128 v[128:131], v28 offset:0
    ds_read_b128 v[132:135], v28 offset:4096
    ds_read_b64_tr_b16 v[136:137], v32 offset:0
    ds_read_b64_tr_b16 v[138:139], v32 offset:1024
    ds_read_b64_tr_b16 v[140:141], v33 offset:0
    ds_read_b64_tr_b16 v[142:143], v33 offset:1024
    ds_read_b128 v[144:147], v29 offset:0
    ds_read_b128 v[148:151], v29 offset:4096
    ds_read_b64_tr_b16 v[152:153], v32 offset:4096
    ds_read_b64_tr_b16 v[154:155], v32 offset:5120
    ds_read_b64_tr_b16 v[156:157], v33 offset:4096
    ds_read_b64_tr_b16 v[158:159], v33 offset:5120
    ds_read_b128 v[160:163], v30 offset:0
    ds_read_b128 v[164:167], v30 offset:4096
    ds_read_b64_tr_b16 v[168:169], v32 offset:8192
    ds_read_b64_tr_b16 v[170:171], v32 offset:9216
    ds_read_b64_tr_b16 v[172:173], v33 offset:8192
    ds_read_b64_tr_b16 v[174:175], v33 offset:9216
    s_waitcnt lgkmcnt(12)
    v_mfma_f32_32x32x16_bf16 v[64:79], v[136:139], v[128:131], v[64:79]
    v_mfma_f32_32x32x16_bf16 v[80:95], v[136:139], v[132:135], v[80:95]
    v_mfma_f32_32x32x16_bf16 v[96:111], v[140:143], v[128:131], v[96:111]
    v_mfma_f32_32x32x16_bf16 v[112:127], v[140:143], v[132:135], v[112:127]
    ds_read_b128 v[128:131], v31 offset:0
    ds_read_b128 v[132:135], v31 offset:4096
    ds_read_b64_tr_b16 v[136:137], v32 offset:12288
    ds_read_b64_tr_b16 v[138:139], v32 offset:13312
    ds_read_b64_tr_b16 v[140:141], v33 offset:12288
    ds_read_b64_tr_b16 v[142:143], v33 offset:13312
    s_waitcnt lgkmcnt(12)
    v_mfma_f32_32x32x16_bf16 v[64:79], v[152:155], v[144:147], v[64:79]
    v_mfma_f32_32x32x16_bf16 v[80:95], v[152:155], v[148:151], v[80:95]
    v_mfma_f32_32x32x16_bf16 v[96:111], v[156:159], v[144:147], v[96:111]
    v_mfma_f32_32x32x16_bf16 v[112:127], v[156:159], v[148:151], v[112:127]
    s_waitcnt lgkmcnt(6)
    v_mfma_f32_32x32x16_bf16 v[64:79], v[168:171], v[160:163], v[64:79]
    v_mfma_f32_32x32x16_bf16 v[80:95], v[168:171], v[164:167], v[80:95]
    v_mfma_f32_32x32x16_bf16 v[96:111], v[172:175], v[160:163], v[96:111]
    v_mfma_f32_32x32x16_bf16 v[112:127], v[172:175], v[164:167], v[112:127]
    s_waitcnt lgkmcnt(0)
    v_mfma_f32_32x32x16_bf16 v[64:79], v[136:139], v[128:131], v[64:79]
    v_mfma_f32_32x32x16_bf16 v[80:95], v[136:139], v[132:135], v[80:95]
    v_mfma_f32_32x32x16_bf16 v[96:111], v[140:143], v[128:131], v[96:111]
    v_mfma_f32_32x32x16_bf16 v[112:127], v[140:143], v[132:135], v[112:127]
    s_waitcnt vmcnt(6)
    s_barrier
    s_mov_b32 s47, 896
    s_mov_b32 s48, 1605632
    s_add_u32 m0, s51, 49152
    s_nop 0
    buffer_load_dwordx4 v10, s[12:15], s47 offen lds
    s_add_u32 m0, s51, 57344
    s_nop 0
    buffer_load_dwordx4 v11, s[12:15], s47 offen lds
    s_add_u32 m0, s51, 65536
    s_nop 0
    buffer_load_dwordx4 v13, s[16:19], s48 offen lds
    s_add_u32 m0, s51, 73728
    s_nop 0
    buffer_load_dwordx4 v14, s[16:19], s48 offen lds
    s_add_u32 m0, s51, 81920
    s_nop 0
    buffer_load_dwordx4 v15, s[20:23], s48 offen lds
    s_add_u32 m0, s51, 90112
    s_nop 0
    buffer_load_dwordx4 v16, s[20:23], s48 offen lds
    ds_read_b128 v[128:131], v36 offset:0
    ds_read_b128 v[132:135], v36 offset:4096
    ds_read_b64_tr_b16 v[136:137], v40 offset:0
    ds_read_b64_tr_b16 v[138:139], v40 offset:1024
    ds_read_b64_tr_b16 v[140:141], v41 offset:0
    ds_read_b64_tr_b16 v[142:143], v41 offset:1024
    ds_read_b128 v[144:147], v37 offset:0
    ds_read_b128 v[148:151], v37 offset:4096
    ds_read_b64_tr_b16 v[152:153], v40 offset:4096
    ds_read_b64_tr_b16 v[154:155], v40 offset:5120
    ds_read_b64_tr_b16 v[156:157], v41 offset:4096
    ds_read_b64_tr_b16 v[158:159], v41 offset:5120
    ds_read_b128 v[160:163], v38 offset:0
    ds_read_b128 v[164:167], v38 offset:4096
    ds_read_b64_tr_b16 v[168:169], v40 offset:8192
    ds_read_b64_tr_b16 v[170:171], v40 offset:9216
    ds_read_b64_tr_b16 v[172:173], v41 offset:8192
    ds_read_b64_tr_b16 v[174:175], v41 offset:9216
    s_waitcnt lgkmcnt(12)
    v_mfma_f32_32x32x16_bf16 v[64:79], v[136:139], v[128:131], v[64:79]
    v_mfma_f32_32x32x16_bf16 v[80:95], v[136:139], v[132:135], v[80:95]
    v_mfma_f32_32x32x16_bf16 v[96:111], v[140:143], v[128:131], v[96:111]
    v_mfma_f32_32x32x16_bf16 v[112:127], v[140:143], v[132:135], v[112:127]
    ds_read_b128 v[128:131], v39 offset:0
    ds_read_b128 v[132:135], v39 offset:4096
    ds_read_b64_tr_b16 v[136:137], v40 offset:12288
    ds_read_b64_tr_b16 v[138:139], v40 offset:13312
    ds_read_b64_tr_b16 v[140:141], v41 offset:12288
    ds_read_b64_tr_b16 v[142:143], v41 offset:13312
    s_waitcnt lgkmcnt(12)
    v_mfma_f32_32x32x16_bf16 v[64:79], v[152:155], v[144:147], v[64:79]
    v_mfma_f32_32x32x16_bf16 v[80:95], v[152:155], v[148:151], v[80:95]
    v_mfma_f32_32x32x16_bf16 v[96:111], v[156:159], v[144:147], v[96:111]
    v_mfma_f32_32x32x16_bf16 v[112:127], v[156:159], v[148:151], v[112:127]
    s_waitcnt lgkmcnt(6)
    v_mfma_f32_32x32x16_bf16 v[64:79], v[168:171], v[160:163], v[64:79]
    v_mfma_f32_32x32x16_bf16 v[80:95], v[168:171], v[164:167], v[80:95]
    v_mfma_f32_32x32x16_bf16 v[96:111], v[172:175], v[160:163], v[96:111]
    v_mfma_f32_32x32x16_bf16 v[112:127], v[172:175], v[164:167], v[112:127]
    s_waitcnt lgkmcnt(0)
    v_mfma_f32_32x32x16_bf16 v[64:79], v[136:139], v[128:131], v[64:79]
    v_mfma_f32_32x32x16_bf16 v[80:95], v[136:139], v[132:135], v[80:95]
    v_mfma_f32_32x32x16_bf16 v[96:111], v[140:143], v[128:131], v[96:111]
    v_mfma_f32_32x32x16_bf16 v[112:127], v[140:143], v[132:135], v[112:127]
    s_waitcnt vmcnt(6)
    s_barrier
    ds_read_b128 v[128:131], v20 offset:0
    ds_read_b128 v[132:135], v20 offset:4096
    ds_read_b64_tr_b16 v[136:137], v24 offset:0
    ds_read_b64_tr_b16 v[138:139], v24 offset:1024
    ds_read_b64_tr_b16 v[140:141], v25 offset:0
    ds_read_b64_tr_b16 v[142:143], v25 offset:1024
    ds_read_b128 v[144:147], v21 offset:0
    ds_read_b128 v[148:151], v21 offset:4096
    ds_read_b64_tr_b16 v[152:153], v24 offset:4096
    ds_read_b64_tr_b16 v[154:155], v24 offset:5120
    ds_read_b64_tr_b16 v[156:157], v25 offset:4096
    ds_read_b64_tr_b16 v[158:159], v25 offset:5120
    ds_read_b128 v[160:163], v22 offset:0
    ds_read_b128 v[164:167], v22 offset:4096
    ds_read_b64_tr_b16 v[168:169], v24 offset:8192
    ds_read_b64_tr_b16 v[170:171], v24 offset:9216
    ds_read_b64_tr_b16 v[172:173], v25 offset:8192
    ds_read_b64_tr_b16 v[174:175], v25 offset:9216
    s_waitcnt lgkmcnt(12)
    v_mfma_f32_32x32x16_bf16 v[64:79], v[136:139], v[128:131], v[64:79]
    v_mfma_f32_32x32x16_bf16 v[80:95], v[136:139], v[132:135], v[80:95]
    v_mfma_f32_32x32x16_bf16 v[96:111], v[140:143], v[128:131], v[96:111]
    v_mfma_f32_32x32x16_bf16 v[112:127], v[140:143], v[132:135], v[112:127]
    ds_read_b128 v[128:131], v23 offset:0
    ds_read_b128 v[132:135], v23 offset:4096
    ds_read_b64_tr_b16 v[136:137], v24 offset:12288
    ds_read_b64_tr_b16 v[138:139], v24 offset:13312
    ds_read_b64_tr_b16 v[140:141], v25 offset:12288
    ds_read_b64_tr_b16 v[142:143], v25 offset:13312
    s_waitcnt lgkmcnt(12)
    v_mfma_f32_32x32x16_bf16 v[64:79], v[152:155], v[144:147], v[64:79]
    v_mfma_f32_32x32x16_bf16 v[80:95], v[152:155], v[148:151], v[80:95]
    v_mfma_f32_32x32x16_bf16 v[96:111], v[156:159], v[144:147], v[96:111]
    v_mfma_f32_32x32x16_bf16 v[112:127], v[156:159], v[148:151], v[112:127]
    s_waitcnt lgkmcnt(6)
    v_mfma_f32_32x32x16_bf16 v[64:79], v[168:171], v[160:163], v[64:79]
    v_mfma_f32_32x32x16_bf16 v[80:95], v[168:171], v[164:167], v[80:95]
    v_mfma_f32_32x32x16_bf16 v[96:111], v[172:175], v[160:163], v[96:111]
    v_mfma_f32_32x32x16_bf16 v[112:127], v[172:175], v[164:167], v[112:127]
    s_waitcnt lgkmcnt(0)
    v_mfma_f32_32x32x16_bf16 v[64:79], v[136:139], v[128:131], v[64:79]
    v_mfma_f32_32x32x16_bf16 v[80:95], v[136:139], v[132:135], v[80:95]
    v_mfma_f32_32x32x16_bf16 v[96:111], v[140:143], v[128:131], v[96:111]
    v_mfma_f32_32x32x16_bf16 v[112:127], v[140:143], v[132:135], v[112:127]
    s_waitcnt vmcnt(0)
    s_barrier
    ds_read_b128 v[128:131], v28 offset:0
    ds_read_b128 v[132:135], v28 offset:4096
    ds_read_b64_tr_b16 v[136:137], v32 offset:0
    ds_read_b64_tr_b16 v[138:139], v32 offset:1024
    ds_read_b64_tr_b16 v[140:141], v33 offset:0
    ds_read_b64_tr_b16 v[142:143], v33 offset:1024
    ds_read_b128 v[144:147], v29 offset:0
    ds_read_b128 v[148:151], v29 offset:4096
    ds_read_b64_tr_b16 v[152:153], v32 offset:4096
    ds_read_b64_tr_b16 v[154:155], v32 offset:5120
    ds_read_b64_tr_b16 v[156:157], v33 offset:4096
    ds_read_b64_tr_b16 v[158:159], v33 offset:5120
    ds_read_b128 v[160:163], v30 offset:0
    ds_read_b128 v[164:167], v30 offset:4096
    ds_read_b64_tr_b16 v[168:169], v32 offset:8192
    ds_read_b64_tr_b16 v[170:171], v32 offset:9216
    ds_read_b64_tr_b16 v[172:173], v33 offset:8192
    ds_read_b64_tr_b16 v[174:175], v33 offset:9216
    s_waitcnt lgkmcnt(12)
    v_mfma_f32_32x32x16_bf16 v[64:79], v[136:139], v[128:131], v[64:79]
    v_mfma_f32_32x32x16_bf16 v[80:95], v[136:139], v[132:135], v[80:95]
    v_mfma_f32_32x32x16_bf16 v[96:111], v[140:143], v[128:131], v[96:111]
    v_mfma_f32_32x32x16_bf16 v[112:127], v[140:143], v[132:135], v[112:127]
    ds_read_b128 v[128:131], v31 offset:0
    ds_read_b128 v[132:135], v31 offset:4096
    ds_read_b64_tr_b16 v[136:137], v32 offset:12288
    ds_read_b64_tr_b16 v[138:139], v32 offset:13312
    ds_read_b64_tr_b16 v[140:141], v33 offset:12288
    ds_read_b64_tr_b16 v[142:143], v33 offset:13312
    s_waitcnt lgkmcnt(12)
    v_mfma_f32_32x32x16_bf16 v[64:79], v[152:155], v[144:147], v[64:79]
    v_mfma_f32_32x32x16_bf16 v[80:95], v[152:155], v[148:151], v[80:95]
    v_mfma_f32_32x32x16_bf16 v[96:111], v[156:159], v[144:147], v[96:111]
    v_mfma_f32_32x32x16_bf16 v[112:127], v[156:159], v[148:151], v[112:127]
    s_waitcnt lgkmcnt(6)
    v_mfma_f32_32x32x16_bf16 v[64:79], v[168:171], v[160:163], v[64:79]
    v_mfma_f32_32x32x16_bf16 v[80:95], v[168:171], v[164:167], v[80:95]
    v_mfma_f32_32x32x16_bf16 v[96:111], v[172:175], v[160:163], v[96:111]
    v_mfma_f32_32x32x16_bf16 v[112:127], v[172:175], v[164:167], v[112:127]
    s_waitcnt lgkmcnt(0)
    v_mfma_f32_32x32x16_bf16 v[64:79], v[136:139], v[128:131], v[64:79]
    v_mfma_f32_32x32x16_bf16 v[80:95], v[136:139], v[132:135], v[80:95]
    v_mfma_f32_32x32x16_bf16 v[96:111], v[140:143], v[128:131], v[96:111]
    v_mfma_f32_32x32x16_bf16 v[112:127], v[140:143], v[132:135], v[112:127]
    s_nop 7
    s_nop 7
    v_and_b32 v3, 31, v1
    v_and_b32 v4, 1, v2
    v_lshlrev_b32 v4, 6, v4
    v_add_u32 v4, v4, v3
    s_lshl_b32 s44, s40, 7
    v_add_u32 v4, s44, v4
    v_lshrrev_b32 v5, 5, v1
    v_lshlrev_b32 v5, 2, v5
    v_lshrrev_b32 v6, 1, v2
    s_add_u32 s24, s8, 72351744
    s_addc_u32 s25, s9, 0
    s_mov_b32 s26, 7340032
    s_mov_b32 s27, 0x00020000
    v_lshlrev_b32 v6, 5, v6
    v_add_u32 v5, v5, v6
    s_lshl_b32 s46, s42, 7
    v_add_u32 v5, s46, v5
    s_mov_b32 s45, 1792
    v_mul_lo_u32 v4, v4, s45
    v_add_u32 v4, v4, v5
    v_lshlrev_b32 v4, 1, v4
    v_add_u32 v5, 114688, v4
    s_mov_b32 s45, 0x3d372713
    s_mov_b32 s46, 0x40135761
    v_cvt_pk_bf16_f32 v64, v64, v64
    v_lshlrev_b32 v64, 16, v64
    v_cvt_pk_bf16_f32 v96, v96, v96
    v_lshlrev_b32 v96, 16, v96
    v_mul_f32 v8, v64, v64
    v_mul_f32 v8, v8, v64
    v_fma_f32 v8, v8, s45, v64
    v_mul_f32 v8, s46, v8
    v_sub_f32 v8, 0, v8
    v_exp_f32 v8, v8
    s_nop 0
    v_add_f32 v8, 1.0, v8
    v_rcp_f32 v8, v8
    s_nop 0
    v_mul_f32 v64, v64, v8
    v_cvt_pk_bf16_f32 v64, v64, v64
    v_lshlrev_b32 v64, 16, v64
    v_mul_f32 v64, v64, v96
    v_cvt_pk_bf16_f32 v65, v65, v65
    v_lshlrev_b32 v65, 16, v65
    v_cvt_pk_bf16_f32 v97, v97, v97
    v_lshlrev_b32 v97, 16, v97
    v_mul_f32 v8, v65, v65
    v_mul_f32 v8, v8, v65
    v_fma_f32 v8, v8, s45, v65
    v_mul_f32 v8, s46, v8
    v_sub_f32 v8, 0, v8
    v_exp_f32 v8, v8
    s_nop 0
    v_add_f32 v8, 1.0, v8
    v_rcp_f32 v8, v8
    s_nop 0
    v_mul_f32 v65, v65, v8
    v_cvt_pk_bf16_f32 v65, v65, v65
    v_lshlrev_b32 v65, 16, v65
    v_mul_f32 v65, v65, v97
    v_cvt_pk_bf16_f32 v66, v66, v66
    v_lshlrev_b32 v66, 16, v66
    v_cvt_pk_bf16_f32 v98, v98, v98
    v_lshlrev_b32 v98, 16, v98
    v_mul_f32 v8, v66, v66
    v_mul_f32 v8, v8, v66
    v_fma_f32 v8, v8, s45, v66
    v_mul_f32 v8, s46, v8
    v_sub_f32 v8, 0, v8
    v_exp_f32 v8, v8
    s_nop 0
    v_add_f32 v8, 1.0, v8
    v_rcp_f32 v8, v8
    s_nop 0
    v_mul_f32 v66, v66, v8
    v_cvt_pk_bf16_f32 v66, v66, v66
    v_lshlrev_b32 v66, 16, v66
    v_mul_f32 v66, v66, v98
    v_cvt_pk_bf16_f32 v67, v67, v67
    v_lshlrev_b32 v67, 16, v67
    v_cvt_pk_bf16_f32 v99, v99, v99
    v_lshlrev_b32 v99, 16, v99
    v_mul_f32 v8, v67, v67
    v_mul_f32 v8, v8, v67
    v_fma_f32 v8, v8, s45, v67
    v_mul_f32 v8, s46, v8
    v_sub_f32 v8, 0, v8
    v_exp_f32 v8, v8
    s_nop 0
    v_add_f32 v8, 1.0, v8
    v_rcp_f32 v8, v8
    s_nop 0
    v_mul_f32 v67, v67, v8
    v_cvt_pk_bf16_f32 v67, v67, v67
    v_lshlrev_b32 v67, 16, v67
    v_mul_f32 v67, v67, v99
    v_cvt_pk_bf16_f32 v68, v68, v68
    v_lshlrev_b32 v68, 16, v68
    v_cvt_pk_bf16_f32 v100, v100, v100
    v_lshlrev_b32 v100, 16, v100
    v_mul_f32 v8, v68, v68
    v_mul_f32 v8, v8, v68
    v_fma_f32 v8, v8, s45, v68
    v_mul_f32 v8, s46, v8
    v_sub_f32 v8, 0, v8
    v_exp_f32 v8, v8
    s_nop 0
    v_add_f32 v8, 1.0, v8
    v_rcp_f32 v8, v8
    s_nop 0
    v_mul_f32 v68, v68, v8
    v_cvt_pk_bf16_f32 v68, v68, v68
    v_lshlrev_b32 v68, 16, v68
    v_mul_f32 v68, v68, v100
    v_cvt_pk_bf16_f32 v69, v69, v69
    v_lshlrev_b32 v69, 16, v69
    v_cvt_pk_bf16_f32 v101, v101, v101
    v_lshlrev_b32 v101, 16, v101
    v_mul_f32 v8, v69, v69
    v_mul_f32 v8, v8, v69
    v_fma_f32 v8, v8, s45, v69
    v_mul_f32 v8, s46, v8
    v_sub_f32 v8, 0, v8
    v_exp_f32 v8, v8
    s_nop 0
    v_add_f32 v8, 1.0, v8
    v_rcp_f32 v8, v8
    s_nop 0
    v_mul_f32 v69, v69, v8
    v_cvt_pk_bf16_f32 v69, v69, v69
    v_lshlrev_b32 v69, 16, v69
    v_mul_f32 v69, v69, v101
    v_cvt_pk_bf16_f32 v70, v70, v70
    v_lshlrev_b32 v70, 16, v70
    v_cvt_pk_bf16_f32 v102, v102, v102
    v_lshlrev_b32 v102, 16, v102
    v_mul_f32 v8, v70, v70
    v_mul_f32 v8, v8, v70
    v_fma_f32 v8, v8, s45, v70
    v_mul_f32 v8, s46, v8
    v_sub_f32 v8, 0, v8
    v_exp_f32 v8, v8
    s_nop 0
    v_add_f32 v8, 1.0, v8
    v_rcp_f32 v8, v8
    s_nop 0
    v_mul_f32 v70, v70, v8
    v_cvt_pk_bf16_f32 v70, v70, v70
    v_lshlrev_b32 v70, 16, v70
    v_mul_f32 v70, v70, v102
    v_cvt_pk_bf16_f32 v71, v71, v71
    v_lshlrev_b32 v71, 16, v71
    v_cvt_pk_bf16_f32 v103, v103, v103
    v_lshlrev_b32 v103, 16, v103
    v_mul_f32 v8, v71, v71
    v_mul_f32 v8, v8, v71
    v_fma_f32 v8, v8, s45, v71
    v_mul_f32 v8, s46, v8
    v_sub_f32 v8, 0, v8
    v_exp_f32 v8, v8
    s_nop 0
    v_add_f32 v8, 1.0, v8
    v_rcp_f32 v8, v8
    s_nop 0
    v_mul_f32 v71, v71, v8
    v_cvt_pk_bf16_f32 v71, v71, v71
    v_lshlrev_b32 v71, 16, v71
    v_mul_f32 v71, v71, v103
    v_cvt_pk_bf16_f32 v72, v72, v72
    v_lshlrev_b32 v72, 16, v72
    v_cvt_pk_bf16_f32 v104, v104, v104
    v_lshlrev_b32 v104, 16, v104
    v_mul_f32 v8, v72, v72
    v_mul_f32 v8, v8, v72
    v_fma_f32 v8, v8, s45, v72
    v_mul_f32 v8, s46, v8
    v_sub_f32 v8, 0, v8
    v_exp_f32 v8, v8
    s_nop 0
    v_add_f32 v8, 1.0, v8
    v_rcp_f32 v8, v8
    s_nop 0
    v_mul_f32 v72, v72, v8
    v_cvt_pk_bf16_f32 v72, v72, v72
    v_lshlrev_b32 v72, 16, v72
    v_mul_f32 v72, v72, v104
    v_cvt_pk_bf16_f32 v73, v73, v73
    v_lshlrev_b32 v73, 16, v73
    v_cvt_pk_bf16_f32 v105, v105, v105
    v_lshlrev_b32 v105, 16, v105
    v_mul_f32 v8, v73, v73
    v_mul_f32 v8, v8, v73
    v_fma_f32 v8, v8, s45, v73
    v_mul_f32 v8, s46, v8
    v_sub_f32 v8, 0, v8
    v_exp_f32 v8, v8
    s_nop 0
    v_add_f32 v8, 1.0, v8
    v_rcp_f32 v8, v8
    s_nop 0
    v_mul_f32 v73, v73, v8
    v_cvt_pk_bf16_f32 v73, v73, v73
    v_lshlrev_b32 v73, 16, v73
    v_mul_f32 v73, v73, v105
    v_cvt_pk_bf16_f32 v74, v74, v74
    v_lshlrev_b32 v74, 16, v74
    v_cvt_pk_bf16_f32 v106, v106, v106
    v_lshlrev_b32 v106, 16, v106
    v_mul_f32 v8, v74, v74
    v_mul_f32 v8, v8, v74
    v_fma_f32 v8, v8, s45, v74
    v_mul_f32 v8, s46, v8
    v_sub_f32 v8, 0, v8
    v_exp_f32 v8, v8
    s_nop 0
    v_add_f32 v8, 1.0, v8
    v_rcp_f32 v8, v8
    s_nop 0
    v_mul_f32 v74, v74, v8
    v_cvt_pk_bf16_f32 v74, v74, v74
    v_lshlrev_b32 v74, 16, v74
    v_mul_f32 v74, v74, v106
    v_cvt_pk_bf16_f32 v75, v75, v75
    v_lshlrev_b32 v75, 16, v75
    v_cvt_pk_bf16_f32 v107, v107, v107
    v_lshlrev_b32 v107, 16, v107
    v_mul_f32 v8, v75, v75
    v_mul_f32 v8, v8, v75
    v_fma_f32 v8, v8, s45, v75
    v_mul_f32 v8, s46, v8
    v_sub_f32 v8, 0, v8
    v_exp_f32 v8, v8
    s_nop 0
    v_add_f32 v8, 1.0, v8
    v_rcp_f32 v8, v8
    s_nop 0
    v_mul_f32 v75, v75, v8
    v_cvt_pk_bf16_f32 v75, v75, v75
    v_lshlrev_b32 v75, 16, v75
    v_mul_f32 v75, v75, v107
    v_cvt_pk_bf16_f32 v76, v76, v76
    v_lshlrev_b32 v76, 16, v76
    v_cvt_pk_bf16_f32 v108, v108, v108
    v_lshlrev_b32 v108, 16, v108
    v_mul_f32 v8, v76, v76
    v_mul_f32 v8, v8, v76
    v_fma_f32 v8, v8, s45, v76
    v_mul_f32 v8, s46, v8
    v_sub_f32 v8, 0, v8
    v_exp_f32 v8, v8
    s_nop 0
    v_add_f32 v8, 1.0, v8
    v_rcp_f32 v8, v8
    s_nop 0
    v_mul_f32 v76, v76, v8
    v_cvt_pk_bf16_f32 v76, v76, v76
    v_lshlrev_b32 v76, 16, v76
    v_mul_f32 v76, v76, v108
    v_cvt_pk_bf16_f32 v77, v77, v77
    v_lshlrev_b32 v77, 16, v77
    v_cvt_pk_bf16_f32 v109, v109, v109
    v_lshlrev_b32 v109, 16, v109
    v_mul_f32 v8, v77, v77
    v_mul_f32 v8, v8, v77
    v_fma_f32 v8, v8, s45, v77
    v_mul_f32 v8, s46, v8
    v_sub_f32 v8, 0, v8
    v_exp_f32 v8, v8
    s_nop 0
    v_add_f32 v8, 1.0, v8
    v_rcp_f32 v8, v8
    s_nop 0
    v_mul_f32 v77, v77, v8
    v_cvt_pk_bf16_f32 v77, v77, v77
    v_lshlrev_b32 v77, 16, v77
    v_mul_f32 v77, v77, v109
    v_cvt_pk_bf16_f32 v78, v78, v78
    v_lshlrev_b32 v78, 16, v78
    v_cvt_pk_bf16_f32 v110, v110, v110
    v_lshlrev_b32 v110, 16, v110
    v_mul_f32 v8, v78, v78
    v_mul_f32 v8, v8, v78
    v_fma_f32 v8, v8, s45, v78
    v_mul_f32 v8, s46, v8
    v_sub_f32 v8, 0, v8
    v_exp_f32 v8, v8
    s_nop 0
    v_add_f32 v8, 1.0, v8
    v_rcp_f32 v8, v8
    s_nop 0
    v_mul_f32 v78, v78, v8
    v_cvt_pk_bf16_f32 v78, v78, v78
    v_lshlrev_b32 v78, 16, v78
    v_mul_f32 v78, v78, v110
    v_cvt_pk_bf16_f32 v79, v79, v79
    v_lshlrev_b32 v79, 16, v79
    v_cvt_pk_bf16_f32 v111, v111, v111
    v_lshlrev_b32 v111, 16, v111
    v_mul_f32 v8, v79, v79
    v_mul_f32 v8, v8, v79
    v_fma_f32 v8, v8, s45, v79
    v_mul_f32 v8, s46, v8
    v_sub_f32 v8, 0, v8
    v_exp_f32 v8, v8
    s_nop 0
    v_add_f32 v8, 1.0, v8
    v_rcp_f32 v8, v8
    s_nop 0
    v_mul_f32 v79, v79, v8
    v_cvt_pk_bf16_f32 v79, v79, v79
    v_lshlrev_b32 v79, 16, v79
    v_mul_f32 v79, v79, v111
    v_cvt_pk_bf16_f32 v8, v64, v65
    v_cvt_pk_bf16_f32 v9, v66, v67
    buffer_store_dwordx2 v[8:9], v4, s[24:27], 0 offen offset:0
    s_nop 1
    v_cvt_pk_bf16_f32 v8, v68, v69
    v_cvt_pk_bf16_f32 v9, v70, v71
    buffer_store_dwordx2 v[8:9], v4, s[24:27], 0 offen offset:16
    s_nop 1
    v_cvt_pk_bf16_f32 v8, v72, v73
    v_cvt_pk_bf16_f32 v9, v74, v75
    buffer_store_dwordx2 v[8:9], v4, s[24:27], 0 offen offset:32
    s_nop 1
    v_cvt_pk_bf16_f32 v8, v76, v77
    v_cvt_pk_bf16_f32 v9, v78, v79
    buffer_store_dwordx2 v[8:9], v4, s[24:27], 0 offen offset:48
    s_nop 1
    v_cvt_pk_bf16_f32 v80, v80, v80
    v_lshlrev_b32 v80, 16, v80
    v_cvt_pk_bf16_f32 v112, v112, v112
    v_lshlrev_b32 v112, 16, v112
    v_mul_f32 v8, v80, v80
    v_mul_f32 v8, v8, v80
    v_fma_f32 v8, v8, s45, v80
    v_mul_f32 v8, s46, v8
    v_sub_f32 v8, 0, v8
    v_exp_f32 v8, v8
    s_nop 0
    v_add_f32 v8, 1.0, v8
    v_rcp_f32 v8, v8
    s_nop 0
    v_mul_f32 v80, v80, v8
    v_cvt_pk_bf16_f32 v80, v80, v80
    v_lshlrev_b32 v80, 16, v80
    v_mul_f32 v80, v80, v112
    v_cvt_pk_bf16_f32 v81, v81, v81
    v_lshlrev_b32 v81, 16, v81
    v_cvt_pk_bf16_f32 v113, v113, v113
    v_lshlrev_b32 v113, 16, v113
    v_mul_f32 v8, v81, v81
    v_mul_f32 v8, v8, v81
    v_fma_f32 v8, v8, s45, v81
    v_mul_f32 v8, s46, v8
    v_sub_f32 v8, 0, v8
    v_exp_f32 v8, v8
    s_nop 0
    v_add_f32 v8, 1.0, v8
    v_rcp_f32 v8, v8
    s_nop 0
    v_mul_f32 v81, v81, v8
    v_cvt_pk_bf16_f32 v81, v81, v81
    v_lshlrev_b32 v81, 16, v81
    v_mul_f32 v81, v81, v113
    v_cvt_pk_bf16_f32 v82, v82, v82
    v_lshlrev_b32 v82, 16, v82
    v_cvt_pk_bf16_f32 v114, v114, v114
    v_lshlrev_b32 v114, 16, v114
    v_mul_f32 v8, v82, v82
    v_mul_f32 v8, v8, v82
    v_fma_f32 v8, v8, s45, v82
    v_mul_f32 v8, s46, v8
    v_sub_f32 v8, 0, v8
    v_exp_f32 v8, v8
    s_nop 0
    v_add_f32 v8, 1.0, v8
    v_rcp_f32 v8, v8
    s_nop 0
    v_mul_f32 v82, v82, v8
    v_cvt_pk_bf16_f32 v82, v82, v82
    v_lshlrev_b32 v82, 16, v82
    v_mul_f32 v82, v82, v114
    v_cvt_pk_bf16_f32 v83, v83, v83
    v_lshlrev_b32 v83, 16, v83
    v_cvt_pk_bf16_f32 v115, v115, v115
    v_lshlrev_b32 v115, 16, v115
    v_mul_f32 v8, v83, v83
    v_mul_f32 v8, v8, v83
    v_fma_f32 v8, v8, s45, v83
    v_mul_f32 v8, s46, v8
    v_sub_f32 v8, 0, v8
    v_exp_f32 v8, v8
    s_nop 0
    v_add_f32 v8, 1.0, v8
    v_rcp_f32 v8, v8
    s_nop 0
    v_mul_f32 v83, v83, v8
    v_cvt_pk_bf16_f32 v83, v83, v83
    v_lshlrev_b32 v83, 16, v83
    v_mul_f32 v83, v83, v115
    v_cvt_pk_bf16_f32 v84, v84, v84
    v_lshlrev_b32 v84, 16, v84
    v_cvt_pk_bf16_f32 v116, v116, v116
    v_lshlrev_b32 v116, 16, v116
    v_mul_f32 v8, v84, v84
    v_mul_f32 v8, v8, v84
    v_fma_f32 v8, v8, s45, v84
    v_mul_f32 v8, s46, v8
    v_sub_f32 v8, 0, v8
    v_exp_f32 v8, v8
    s_nop 0
    v_add_f32 v8, 1.0, v8
    v_rcp_f32 v8, v8
    s_nop 0
    v_mul_f32 v84, v84, v8
    v_cvt_pk_bf16_f32 v84, v84, v84
    v_lshlrev_b32 v84, 16, v84
    v_mul_f32 v84, v84, v116
    v_cvt_pk_bf16_f32 v85, v85, v85
    v_lshlrev_b32 v85, 16, v85
    v_cvt_pk_bf16_f32 v117, v117, v117
    v_lshlrev_b32 v117, 16, v117
    v_mul_f32 v8, v85, v85
    v_mul_f32 v8, v8, v85
    v_fma_f32 v8, v8, s45, v85
    v_mul_f32 v8, s46, v8
    v_sub_f32 v8, 0, v8
    v_exp_f32 v8, v8
    s_nop 0
    v_add_f32 v8, 1.0, v8
    v_rcp_f32 v8, v8
    s_nop 0
    v_mul_f32 v85, v85, v8
    v_cvt_pk_bf16_f32 v85, v85, v85
    v_lshlrev_b32 v85, 16, v85
    v_mul_f32 v85, v85, v117
    v_cvt_pk_bf16_f32 v86, v86, v86
    v_lshlrev_b32 v86, 16, v86
    v_cvt_pk_bf16_f32 v118, v118, v118
    v_lshlrev_b32 v118, 16, v118
    v_mul_f32 v8, v86, v86
    v_mul_f32 v8, v8, v86
    v_fma_f32 v8, v8, s45, v86
    v_mul_f32 v8, s46, v8
    v_sub_f32 v8, 0, v8
    v_exp_f32 v8, v8
    s_nop 0
    v_add_f32 v8, 1.0, v8
    v_rcp_f32 v8, v8
    s_nop 0
    v_mul_f32 v86, v86, v8
    v_cvt_pk_bf16_f32 v86, v86, v86
    v_lshlrev_b32 v86, 16, v86
    v_mul_f32 v86, v86, v118
    v_cvt_pk_bf16_f32 v87, v87, v87
    v_lshlrev_b32 v87, 16, v87
    v_cvt_pk_bf16_f32 v119, v119, v119
    v_lshlrev_b32 v119, 16, v119
    v_mul_f32 v8, v87, v87
    v_mul_f32 v8, v8, v87
    v_fma_f32 v8, v8, s45, v87
    v_mul_f32 v8, s46, v8
    v_sub_f32 v8, 0, v8
    v_exp_f32 v8, v8
    s_nop 0
    v_add_f32 v8, 1.0, v8
    v_rcp_f32 v8, v8
    s_nop 0
    v_mul_f32 v87, v87, v8
    v_cvt_pk_bf16_f32 v87, v87, v87
    v_lshlrev_b32 v87, 16, v87
    v_mul_f32 v87, v87, v119
    v_cvt_pk_bf16_f32 v88, v88, v88
    v_lshlrev_b32 v88, 16, v88
    v_cvt_pk_bf16_f32 v120, v120, v120
    v_lshlrev_b32 v120, 16, v120
    v_mul_f32 v8, v88, v88
    v_mul_f32 v8, v8, v88
    v_fma_f32 v8, v8, s45, v88
    v_mul_f32 v8, s46, v8
    v_sub_f32 v8, 0, v8
    v_exp_f32 v8, v8
    s_nop 0
    v_add_f32 v8, 1.0, v8
    v_rcp_f32 v8, v8
    s_nop 0
    v_mul_f32 v88, v88, v8
    v_cvt_pk_bf16_f32 v88, v88, v88
    v_lshlrev_b32 v88, 16, v88
    v_mul_f32 v88, v88, v120
    v_cvt_pk_bf16_f32 v89, v89, v89
    v_lshlrev_b32 v89, 16, v89
    v_cvt_pk_bf16_f32 v121, v121, v121
    v_lshlrev_b32 v121, 16, v121
    v_mul_f32 v8, v89, v89
    v_mul_f32 v8, v8, v89
    v_fma_f32 v8, v8, s45, v89
    v_mul_f32 v8, s46, v8
    v_sub_f32 v8, 0, v8
    v_exp_f32 v8, v8
    s_nop 0
    v_add_f32 v8, 1.0, v8
    v_rcp_f32 v8, v8
    s_nop 0
    v_mul_f32 v89, v89, v8
    v_cvt_pk_bf16_f32 v89, v89, v89
    v_lshlrev_b32 v89, 16, v89
    v_mul_f32 v89, v89, v121
    v_cvt_pk_bf16_f32 v90, v90, v90
    v_lshlrev_b32 v90, 16, v90
    v_cvt_pk_bf16_f32 v122, v122, v122
    v_lshlrev_b32 v122, 16, v122
    v_mul_f32 v8, v90, v90
    v_mul_f32 v8, v8, v90
    v_fma_f32 v8, v8, s45, v90
    v_mul_f32 v8, s46, v8
    v_sub_f32 v8, 0, v8
    v_exp_f32 v8, v8
    s_nop 0
    v_add_f32 v8, 1.0, v8
    v_rcp_f32 v8, v8
    s_nop 0
    v_mul_f32 v90, v90, v8
    v_cvt_pk_bf16_f32 v90, v90, v90
    v_lshlrev_b32 v90, 16, v90
    v_mul_f32 v90, v90, v122
    v_cvt_pk_bf16_f32 v91, v91, v91
    v_lshlrev_b32 v91, 16, v91
    v_cvt_pk_bf16_f32 v123, v123, v123
    v_lshlrev_b32 v123, 16, v123
    v_mul_f32 v8, v91, v91
    v_mul_f32 v8, v8, v91
    v_fma_f32 v8, v8, s45, v91
    v_mul_f32 v8, s46, v8
    v_sub_f32 v8, 0, v8
    v_exp_f32 v8, v8
    s_nop 0
    v_add_f32 v8, 1.0, v8
    v_rcp_f32 v8, v8
    s_nop 0
    v_mul_f32 v91, v91, v8
    v_cvt_pk_bf16_f32 v91, v91, v91
    v_lshlrev_b32 v91, 16, v91
    v_mul_f32 v91, v91, v123
    v_cvt_pk_bf16_f32 v92, v92, v92
    v_lshlrev_b32 v92, 16, v92
    v_cvt_pk_bf16_f32 v124, v124, v124
    v_lshlrev_b32 v124, 16, v124
    v_mul_f32 v8, v92, v92
    v_mul_f32 v8, v8, v92
    v_fma_f32 v8, v8, s45, v92
    v_mul_f32 v8, s46, v8
    v_sub_f32 v8, 0, v8
    v_exp_f32 v8, v8
    s_nop 0
    v_add_f32 v8, 1.0, v8
    v_rcp_f32 v8, v8
    s_nop 0
    v_mul_f32 v92, v92, v8
    v_cvt_pk_bf16_f32 v92, v92, v92
    v_lshlrev_b32 v92, 16, v92
    v_mul_f32 v92, v92, v124
    v_cvt_pk_bf16_f32 v93, v93, v93
    v_lshlrev_b32 v93, 16, v93
    v_cvt_pk_bf16_f32 v125, v125, v125
    v_lshlrev_b32 v125, 16, v125
    v_mul_f32 v8, v93, v93
    v_mul_f32 v8, v8, v93
    v_fma_f32 v8, v8, s45, v93
    v_mul_f32 v8, s46, v8
    v_sub_f32 v8, 0, v8
    v_exp_f32 v8, v8
    s_nop 0
    v_add_f32 v8, 1.0, v8
    v_rcp_f32 v8, v8
    s_nop 0
    v_mul_f32 v93, v93, v8
    v_cvt_pk_bf16_f32 v93, v93, v93
    v_lshlrev_b32 v93, 16, v93
    v_mul_f32 v93, v93, v125
    v_cvt_pk_bf16_f32 v94, v94, v94
    v_lshlrev_b32 v94, 16, v94
    v_cvt_pk_bf16_f32 v126, v126, v126
    v_lshlrev_b32 v126, 16, v126
    v_mul_f32 v8, v94, v94
    v_mul_f32 v8, v8, v94
    v_fma_f32 v8, v8, s45, v94
    v_mul_f32 v8, s46, v8
    v_sub_f32 v8, 0, v8
    v_exp_f32 v8, v8
    s_nop 0
    v_add_f32 v8, 1.0, v8
    v_rcp_f32 v8, v8
    s_nop 0
    v_mul_f32 v94, v94, v8
    v_cvt_pk_bf16_f32 v94, v94, v94
    v_lshlrev_b32 v94, 16, v94
    v_mul_f32 v94, v94, v126
    v_cvt_pk_bf16_f32 v95, v95, v95
    v_lshlrev_b32 v95, 16, v95
    v_cvt_pk_bf16_f32 v127, v127, v127
    v_lshlrev_b32 v127, 16, v127
    v_mul_f32 v8, v95, v95
    v_mul_f32 v8, v8, v95
    v_fma_f32 v8, v8, s45, v95
    v_mul_f32 v8, s46, v8
    v_sub_f32 v8, 0, v8
    v_exp_f32 v8, v8
    s_nop 0
    v_add_f32 v8, 1.0, v8
    v_rcp_f32 v8, v8
    s_nop 0
    v_mul_f32 v95, v95, v8
    v_cvt_pk_bf16_f32 v95, v95, v95
    v_lshlrev_b32 v95, 16, v95
    v_mul_f32 v95, v95, v127
    v_cvt_pk_bf16_f32 v8, v80, v81
    v_cvt_pk_bf16_f32 v9, v82, v83
    buffer_store_dwordx2 v[8:9], v5, s[24:27], 0 offen offset:0
    s_nop 1
    v_cvt_pk_bf16_f32 v8, v84, v85
    v_cvt_pk_bf16_f32 v9, v86, v87
    buffer_store_dwordx2 v[8:9], v5, s[24:27], 0 offen offset:16
    s_nop 1
    v_cvt_pk_bf16_f32 v8, v88, v89
    v_cvt_pk_bf16_f32 v9, v90, v91
    buffer_store_dwordx2 v[8:9], v5, s[24:27], 0 offen offset:32
    s_nop 1
    v_cvt_pk_bf16_f32 v8, v92, v93
    v_cvt_pk_bf16_f32 v9, v94, v95
    buffer_store_dwordx2 v[8:9], v5, s[24:27], 0 offen offset:48
    s_nop 1
gateup_kernel_done:
    s_endpgm
.globl down_kernel
.p2align 8
.type down_kernel,@function
down_kernel:
    s_cmp_ge_u32 s2, 224
    s_cbranch_scc1 down_kernel_done
    s_load_dwordx2 s[4:5], s[0:1], 64
    s_load_dwordx2 s[6:7], s[0:1], 64
    s_load_dwordx2 s[8:9], s[0:1], 104
    s_and_b32 s40, s2, 15
    s_lshr_b32 s41, s2, 4
    s_and_b32 s42, s41, 1
    s_lshr_b32 s43, s41, 1
    v_and_b32 v1, 63, v0
    v_lshrrev_b32 v2, 6, v0
    s_nop 0
    v_readfirstlane_b32 s50, v2
    s_waitcnt lgkmcnt(0)
    s_add_u32 s12, s8, 72351744
    s_addc_u32 s13, s9, 0
    s_mov_b32 s14, 7340032
    s_mov_b32 s15, 0x00020000
    s_mov_b32 s16, s4
    s_mov_b32 s17, s5
    s_mov_b32 s18, 1835008
    s_mov_b32 s19, 0x00020000
    s_mov_b32 s20, s6
    s_mov_b32 s21, s7
    s_mov_b32 s22, 1835008
    s_mov_b32 s23, 0x00020000
    v_lshrrev_b32 v3, 3, v1
    v_lshlrev_b32 v4, 3, v2
    v_add_u32 v3, v3, v4
    v_lshrrev_b32 v5, 1, v3
    v_and_b32 v5, 7, v5
    v_and_b32 v4, 7, v1
    v_xor_b32 v4, v4, v5
    s_lshl_b32 s44, s40, 7
    v_add_u32 v5, s44, v3
    s_mov_b32 s45, 3584
    v_mul_lo_u32 v5, v5, s45
    v_lshlrev_b32 v6, 4, v4
    v_add_u32 v5, v5, v6
    s_mul_i32 s46, s43, 512
    v_add_u32 v10, s46, v5
    v_add_u32 v11, 229376, v10
    s_lshl_b32 s51, s50, 10
    v_lshrrev_b32 v3, 5, v1
    v_lshlrev_b32 v4, 1, v2
    v_add_u32 v3, v3, v4
    v_and_b32 v5, 3, v3
    v_lshlrev_b32 v5, 2, v5
    v_and_b32 v4, 31, v1
    v_xor_b32 v4, v4, v5
    s_mul_i32 s46, s43, 256
    v_add_u32 v5, s46, v3
    s_mov_b32 s45, 1024
    v_mul_lo_u32 v5, v5, s45
    v_lshlrev_b32 v6, 4, v4
    v_add_u32 v5, v5, v6
    s_lshl_b32 s46, s42, 9
    v_add_u32 v13, s46, v5
    v_add_u32 v14, 16384, v13
    v_add_u32 v15, 32768, v13
    v_add_u32 v16, 49152, v13
    v_and_b32 v3, 31, v1
    v_and_b32 v4, 1, v2
    v_lshlrev_b32 v4, 6, v4
    v_add_u32 v4, v4, v3
    v_lshrrev_b32 v5, 1, v4
    v_and_b32 v5, 7, v5
    v_lshrrev_b32 v6, 5, v1
    v_lshlrev_b32 v7, 7, v4
    v_add_u32 v8, 0, v6
    v_xor_b32 v8, v8, v5
    v_lshlrev_b32 v8, 4, v8
    v_add_u32 v20, v7, v8
    v_add_u32 v8, 2, v6
    v_xor_b32 v8, v8, v5
    v_lshlrev_b32 v8, 4, v8
    v_add_u32 v21, v7, v8
    v_add_u32 v8, 4, v6
    v_xor_b32 v8, v8, v5
    v_lshlrev_b32 v8, 4, v8
    v_add_u32 v22, v7, v8
    v_add_u32 v8, 6, v6
    v_xor_b32 v8, v8, v5
    v_lshlrev_b32 v8, 4, v8
    v_add_u32 v23, v7, v8
    v_lshrrev_b32 v3, 4, v1
    v_and_b32 v4, 15, v1
    v_lshrrev_b32 v5, 1, v2
    v_lshlrev_b32 v5, 3, v5
    v_and_b32 v6, 1, v3
    v_lshlrev_b32 v6, 1, v6
    v_add_u32 v5, v5, v6
    v_and_b32 v6, 3, v4
    v_lshrrev_b32 v6, 1, v6
    v_add_u32 v5, v5, v6
    v_lshrrev_b32 v6, 2, v4
    v_lshrrev_b32 v7, 1, v3
    v_lshlrev_b32 v7, 3, v7
    v_add_u32 v7, v7, v6
    v_lshlrev_b32 v7, 9, v7
    v_and_b32 v8, 1, v4
    v_lshlrev_b32 v8, 3, v8
    v_add_u32 v7, v7, v8
    v_lshlrev_b32 v6, 2, v6
    v_add_u32 v8, 0, v5
    v_xor_b32 v8, v8, v6
    v_lshlrev_b32 v8, 4, v8
    v_add_u32 v8, v8, v7
    v_add_u32 v24, 16384, v8
    v_add_u32 v8, 4, v5
    v_xor_b32 v8, v8, v6
    v_lshlrev_b32 v8, 4, v8
    v_add_u32 v8, v8, v7
    v_add_u32 v25, 16384, v8
    v_add_u32 v28, 49152, v20
    v_add_u32 v29, 49152, v21
    v_add_u32 v30, 49152, v22
    v_add_u32 v31, 49152, v23
    v_add_u32 v32, 49152, v24
    v_add_u32 v33, 49152, v25
    v_add_u32 v36, 98304, v20
    v_add_u32 v37, 98304, v21
    v_add_u32 v38, 98304, v22
    v_add_u32 v39, 98304, v23
    v_add_u32 v40, 98304, v24
    v_add_u32 v41, 98304, v25
    v_mov_b32 v64, 0
    v_mov_b32 v65, 0
    v_mov_b32 v66, 0
    v_mov_b32 v67, 0
    v_mov_b32 v68, 0
    v_mov_b32 v69, 0
    v_mov_b32 v70, 0
    v_mov_b32 v71, 0
    v_mov_b32 v72, 0
    v_mov_b32 v73, 0
    v_mov_b32 v74, 0
    v_mov_b32 v75, 0
    v_mov_b32 v76, 0
    v_mov_b32 v77, 0
    v_mov_b32 v78, 0
    v_mov_b32 v79, 0
    v_mov_b32 v80, 0
    v_mov_b32 v81, 0
    v_mov_b32 v82, 0
    v_mov_b32 v83, 0
    v_mov_b32 v84, 0
    v_mov_b32 v85, 0
    v_mov_b32 v86, 0
    v_mov_b32 v87, 0
    v_mov_b32 v88, 0
    v_mov_b32 v89, 0
    v_mov_b32 v90, 0
    v_mov_b32 v91, 0
    v_mov_b32 v92, 0
    v_mov_b32 v93, 0
    v_mov_b32 v94, 0
    v_mov_b32 v95, 0
    v_mov_b32 v96, 0
    v_mov_b32 v97, 0
    v_mov_b32 v98, 0
    v_mov_b32 v99, 0
    v_mov_b32 v100, 0
    v_mov_b32 v101, 0
    v_mov_b32 v102, 0
    v_mov_b32 v103, 0
    v_mov_b32 v104, 0
    v_mov_b32 v105, 0
    v_mov_b32 v106, 0
    v_mov_b32 v107, 0
    v_mov_b32 v108, 0
    v_mov_b32 v109, 0
    v_mov_b32 v110, 0
    v_mov_b32 v111, 0
    v_mov_b32 v112, 0
    v_mov_b32 v113, 0
    v_mov_b32 v114, 0
    v_mov_b32 v115, 0
    v_mov_b32 v116, 0
    v_mov_b32 v117, 0
    v_mov_b32 v118, 0
    v_mov_b32 v119, 0
    v_mov_b32 v120, 0
    v_mov_b32 v121, 0
    v_mov_b32 v122, 0
    v_mov_b32 v123, 0
    v_mov_b32 v124, 0
    v_mov_b32 v125, 0
    v_mov_b32 v126, 0
    v_mov_b32 v127, 0
    s_mov_b32 s47, 0
    s_mov_b32 s48, 0
    s_add_u32 m0, s51, 0
    s_nop 0
    buffer_load_dwordx4 v10, s[12:15], s47 offen lds
    s_add_u32 m0, s51, 8192
    s_nop 0
    buffer_load_dwordx4 v11, s[12:15], s47 offen lds
    s_add_u32 m0, s51, 16384
    s_nop 0
    buffer_load_dwordx4 v13, s[16:19], s48 offen lds
    s_add_u32 m0, s51, 24576
    s_nop 0
    buffer_load_dwordx4 v14, s[16:19], s48 offen lds
    s_add_u32 m0, s51, 32768
    s_nop 0
    buffer_load_dwordx4 v15, s[16:19], s48 offen lds
    s_add_u32 m0, s51, 40960
    s_nop 0
    buffer_load_dwordx4 v16, s[16:19], s48 offen lds
    s_mov_b32 s47, 128
    s_mov_b32 s48, 65536
    s_add_u32 m0, s51, 49152
    s_nop 0
    buffer_load_dwordx4 v10, s[12:15], s47 offen lds
    s_add_u32 m0, s51, 57344
    s_nop 0
    buffer_load_dwordx4 v11, s[12:15], s47 offen lds
    s_add_u32 m0, s51, 65536
    s_nop 0
    buffer_load_dwordx4 v13, s[16:19], s48 offen lds
    s_add_u32 m0, s51, 73728
    s_nop 0
    buffer_load_dwordx4 v14, s[16:19], s48 offen lds
    s_add_u32 m0, s51, 81920
    s_nop 0
    buffer_load_dwordx4 v15, s[16:19], s48 offen lds
    s_add_u32 m0, s51, 90112
    s_nop 0
    buffer_load_dwordx4 v16, s[16:19], s48 offen lds
    s_waitcnt vmcnt(6)
    s_barrier
    s_mov_b32 s47, 256
    s_mov_b32 s48, 131072
    s_add_u32 m0, s51, 98304
    s_nop 0
    buffer_load_dwordx4 v10, s[12:15], s47 offen lds
    s_add_u32 m0, s51, 106496
    s_nop 0
    buffer_load_dwordx4 v11, s[12:15], s47 offen lds
    s_add_u32 m0, s51, 114688
    s_nop 0
    buffer_load_dwordx4 v13, s[16:19], s48 offen lds
    s_add_u32 m0, s51, 122880
    s_nop 0
    buffer_load_dwordx4 v14, s[16:19], s48 offen lds
    s_add_u32 m0, s51, 131072
    s_nop 0
    buffer_load_dwordx4 v15, s[16:19], s48 offen lds
    s_add_u32 m0, s51, 139264
    s_nop 0
    buffer_load_dwordx4 v16, s[16:19], s48 offen lds
    ds_read_b128 v[128:131], v20 offset:0
    ds_read_b128 v[132:135], v20 offset:4096
    ds_read_b64_tr_b16 v[136:137], v24 offset:0
    ds_read_b64_tr_b16 v[138:139], v24 offset:2048
    ds_read_b64_tr_b16 v[140:141], v25 offset:0
    ds_read_b64_tr_b16 v[142:143], v25 offset:2048
    ds_read_b128 v[144:147], v21 offset:0
    ds_read_b128 v[148:151], v21 offset:4096
    ds_read_b64_tr_b16 v[152:153], v24 offset:8192
    ds_read_b64_tr_b16 v[154:155], v24 offset:10240
    ds_read_b64_tr_b16 v[156:157], v25 offset:8192
    ds_read_b64_tr_b16 v[158:159], v25 offset:10240
    ds_read_b128 v[160:163], v22 offset:0
    ds_read_b128 v[164:167], v22 offset:4096
    ds_read_b64_tr_b16 v[168:169], v24 offset:16384
    ds_read_b64_tr_b16 v[170:171], v24 offset:18432
    ds_read_b64_tr_b16 v[172:173], v25 offset:16384
    ds_read_b64_tr_b16 v[174:175], v25 offset:18432
    s_waitcnt lgkmcnt(12)
    v_mfma_f32_32x32x16_bf16 v[64:79], v[136:139], v[128:131], v[64:79]
    v_mfma_f32_32x32x16_bf16 v[80:95], v[136:139], v[132:135], v[80:95]
    v_mfma_f32_32x32x16_bf16 v[96:111], v[140:143], v[128:131], v[96:111]
    v_mfma_f32_32x32x16_bf16 v[112:127], v[140:143], v[132:135], v[112:127]
    ds_read_b128 v[128:131], v23 offset:0
    ds_read_b128 v[132:135], v23 offset:4096
    ds_read_b64_tr_b16 v[136:137], v24 offset:24576
    ds_read_b64_tr_b16 v[138:139], v24 offset:26624
    ds_read_b64_tr_b16 v[140:141], v25 offset:24576
    ds_read_b64_tr_b16 v[142:143], v25 offset:26624
    s_waitcnt lgkmcnt(12)
    v_mfma_f32_32x32x16_bf16 v[64:79], v[152:155], v[144:147], v[64:79]
    v_mfma_f32_32x32x16_bf16 v[80:95], v[152:155], v[148:151], v[80:95]
    v_mfma_f32_32x32x16_bf16 v[96:111], v[156:159], v[144:147], v[96:111]
    v_mfma_f32_32x32x16_bf16 v[112:127], v[156:159], v[148:151], v[112:127]
    s_waitcnt lgkmcnt(6)
    v_mfma_f32_32x32x16_bf16 v[64:79], v[168:171], v[160:163], v[64:79]
    v_mfma_f32_32x32x16_bf16 v[80:95], v[168:171], v[164:167], v[80:95]
    v_mfma_f32_32x32x16_bf16 v[96:111], v[172:175], v[160:163], v[96:111]
    v_mfma_f32_32x32x16_bf16 v[112:127], v[172:175], v[164:167], v[112:127]
    s_waitcnt lgkmcnt(0)
    v_mfma_f32_32x32x16_bf16 v[64:79], v[136:139], v[128:131], v[64:79]
    v_mfma_f32_32x32x16_bf16 v[80:95], v[136:139], v[132:135], v[80:95]
    v_mfma_f32_32x32x16_bf16 v[96:111], v[140:143], v[128:131], v[96:111]
    v_mfma_f32_32x32x16_bf16 v[112:127], v[140:143], v[132:135], v[112:127]
    s_waitcnt vmcnt(6)
    s_barrier
    s_mov_b32 s47, 384
    s_mov_b32 s48, 196608
    s_add_u32 m0, s51, 0
    s_nop 0
    buffer_load_dwordx4 v10, s[12:15], s47 offen lds
    s_add_u32 m0, s51, 8192
    s_nop 0
    buffer_load_dwordx4 v11, s[12:15], s47 offen lds
    s_add_u32 m0, s51, 16384
    s_nop 0
    buffer_load_dwordx4 v13, s[16:19], s48 offen lds
    s_add_u32 m0, s51, 24576
    s_nop 0
    buffer_load_dwordx4 v14, s[16:19], s48 offen lds
    s_add_u32 m0, s51, 32768
    s_nop 0
    buffer_load_dwordx4 v15, s[16:19], s48 offen lds
    s_add_u32 m0, s51, 40960
    s_nop 0
    buffer_load_dwordx4 v16, s[16:19], s48 offen lds
    ds_read_b128 v[128:131], v28 offset:0
    ds_read_b128 v[132:135], v28 offset:4096
    ds_read_b64_tr_b16 v[136:137], v32 offset:0
    ds_read_b64_tr_b16 v[138:139], v32 offset:2048
    ds_read_b64_tr_b16 v[140:141], v33 offset:0
    ds_read_b64_tr_b16 v[142:143], v33 offset:2048
    ds_read_b128 v[144:147], v29 offset:0
    ds_read_b128 v[148:151], v29 offset:4096
    ds_read_b64_tr_b16 v[152:153], v32 offset:8192
    ds_read_b64_tr_b16 v[154:155], v32 offset:10240
    ds_read_b64_tr_b16 v[156:157], v33 offset:8192
    ds_read_b64_tr_b16 v[158:159], v33 offset:10240
    ds_read_b128 v[160:163], v30 offset:0
    ds_read_b128 v[164:167], v30 offset:4096
    ds_read_b64_tr_b16 v[168:169], v32 offset:16384
    ds_read_b64_tr_b16 v[170:171], v32 offset:18432
    ds_read_b64_tr_b16 v[172:173], v33 offset:16384
    ds_read_b64_tr_b16 v[174:175], v33 offset:18432
    s_waitcnt lgkmcnt(12)
    v_mfma_f32_32x32x16_bf16 v[64:79], v[136:139], v[128:131], v[64:79]
    v_mfma_f32_32x32x16_bf16 v[80:95], v[136:139], v[132:135], v[80:95]
    v_mfma_f32_32x32x16_bf16 v[96:111], v[140:143], v[128:131], v[96:111]
    v_mfma_f32_32x32x16_bf16 v[112:127], v[140:143], v[132:135], v[112:127]
    ds_read_b128 v[128:131], v31 offset:0
    ds_read_b128 v[132:135], v31 offset:4096
    ds_read_b64_tr_b16 v[136:137], v32 offset:24576
    ds_read_b64_tr_b16 v[138:139], v32 offset:26624
    ds_read_b64_tr_b16 v[140:141], v33 offset:24576
    ds_read_b64_tr_b16 v[142:143], v33 offset:26624
    s_waitcnt lgkmcnt(12)
    v_mfma_f32_32x32x16_bf16 v[64:79], v[152:155], v[144:147], v[64:79]
    v_mfma_f32_32x32x16_bf16 v[80:95], v[152:155], v[148:151], v[80:95]
    v_mfma_f32_32x32x16_bf16 v[96:111], v[156:159], v[144:147], v[96:111]
    v_mfma_f32_32x32x16_bf16 v[112:127], v[156:159], v[148:151], v[112:127]
    s_waitcnt lgkmcnt(6)
    v_mfma_f32_32x32x16_bf16 v[64:79], v[168:171], v[160:163], v[64:79]
    v_mfma_f32_32x32x16_bf16 v[80:95], v[168:171], v[164:167], v[80:95]
    v_mfma_f32_32x32x16_bf16 v[96:111], v[172:175], v[160:163], v[96:111]
    v_mfma_f32_32x32x16_bf16 v[112:127], v[172:175], v[164:167], v[112:127]
    s_waitcnt lgkmcnt(0)
    v_mfma_f32_32x32x16_bf16 v[64:79], v[136:139], v[128:131], v[64:79]
    v_mfma_f32_32x32x16_bf16 v[80:95], v[136:139], v[132:135], v[80:95]
    v_mfma_f32_32x32x16_bf16 v[96:111], v[140:143], v[128:131], v[96:111]
    v_mfma_f32_32x32x16_bf16 v[112:127], v[140:143], v[132:135], v[112:127]
    s_waitcnt vmcnt(6)
    s_barrier
    ds_read_b128 v[128:131], v36 offset:0
    ds_read_b128 v[132:135], v36 offset:4096
    ds_read_b64_tr_b16 v[136:137], v40 offset:0
    ds_read_b64_tr_b16 v[138:139], v40 offset:2048
    ds_read_b64_tr_b16 v[140:141], v41 offset:0
    ds_read_b64_tr_b16 v[142:143], v41 offset:2048
    ds_read_b128 v[144:147], v37 offset:0
    ds_read_b128 v[148:151], v37 offset:4096
    ds_read_b64_tr_b16 v[152:153], v40 offset:8192
    ds_read_b64_tr_b16 v[154:155], v40 offset:10240
    ds_read_b64_tr_b16 v[156:157], v41 offset:8192
    ds_read_b64_tr_b16 v[158:159], v41 offset:10240
    ds_read_b128 v[160:163], v38 offset:0
    ds_read_b128 v[164:167], v38 offset:4096
    ds_read_b64_tr_b16 v[168:169], v40 offset:16384
    ds_read_b64_tr_b16 v[170:171], v40 offset:18432
    ds_read_b64_tr_b16 v[172:173], v41 offset:16384
    ds_read_b64_tr_b16 v[174:175], v41 offset:18432
    s_waitcnt lgkmcnt(12)
    v_mfma_f32_32x32x16_bf16 v[64:79], v[136:139], v[128:131], v[64:79]
    v_mfma_f32_32x32x16_bf16 v[80:95], v[136:139], v[132:135], v[80:95]
    v_mfma_f32_32x32x16_bf16 v[96:111], v[140:143], v[128:131], v[96:111]
    v_mfma_f32_32x32x16_bf16 v[112:127], v[140:143], v[132:135], v[112:127]
    ds_read_b128 v[128:131], v39 offset:0
    ds_read_b128 v[132:135], v39 offset:4096
    ds_read_b64_tr_b16 v[136:137], v40 offset:24576
    ds_read_b64_tr_b16 v[138:139], v40 offset:26624
    ds_read_b64_tr_b16 v[140:141], v41 offset:24576
    ds_read_b64_tr_b16 v[142:143], v41 offset:26624
    s_waitcnt lgkmcnt(12)
    v_mfma_f32_32x32x16_bf16 v[64:79], v[152:155], v[144:147], v[64:79]
    v_mfma_f32_32x32x16_bf16 v[80:95], v[152:155], v[148:151], v[80:95]
    v_mfma_f32_32x32x16_bf16 v[96:111], v[156:159], v[144:147], v[96:111]
    v_mfma_f32_32x32x16_bf16 v[112:127], v[156:159], v[148:151], v[112:127]
    s_waitcnt lgkmcnt(6)
    v_mfma_f32_32x32x16_bf16 v[64:79], v[168:171], v[160:163], v[64:79]
    v_mfma_f32_32x32x16_bf16 v[80:95], v[168:171], v[164:167], v[80:95]
    v_mfma_f32_32x32x16_bf16 v[96:111], v[172:175], v[160:163], v[96:111]
    v_mfma_f32_32x32x16_bf16 v[112:127], v[172:175], v[164:167], v[112:127]
    s_waitcnt lgkmcnt(0)
    v_mfma_f32_32x32x16_bf16 v[64:79], v[136:139], v[128:131], v[64:79]
    v_mfma_f32_32x32x16_bf16 v[80:95], v[136:139], v[132:135], v[80:95]
    v_mfma_f32_32x32x16_bf16 v[96:111], v[140:143], v[128:131], v[96:111]
    v_mfma_f32_32x32x16_bf16 v[112:127], v[140:143], v[132:135], v[112:127]
    s_waitcnt vmcnt(0)
    s_barrier
    ds_read_b128 v[128:131], v20 offset:0
    ds_read_b128 v[132:135], v20 offset:4096
    ds_read_b64_tr_b16 v[136:137], v24 offset:0
    ds_read_b64_tr_b16 v[138:139], v24 offset:2048
    ds_read_b64_tr_b16 v[140:141], v25 offset:0
    ds_read_b64_tr_b16 v[142:143], v25 offset:2048
    ds_read_b128 v[144:147], v21 offset:0
    ds_read_b128 v[148:151], v21 offset:4096
    ds_read_b64_tr_b16 v[152:153], v24 offset:8192
    ds_read_b64_tr_b16 v[154:155], v24 offset:10240
    ds_read_b64_tr_b16 v[156:157], v25 offset:8192
    ds_read_b64_tr_b16 v[158:159], v25 offset:10240
    ds_read_b128 v[160:163], v22 offset:0
    ds_read_b128 v[164:167], v22 offset:4096
    ds_read_b64_tr_b16 v[168:169], v24 offset:16384
    ds_read_b64_tr_b16 v[170:171], v24 offset:18432
    ds_read_b64_tr_b16 v[172:173], v25 offset:16384
    ds_read_b64_tr_b16 v[174:175], v25 offset:18432
    s_waitcnt lgkmcnt(12)
    v_mfma_f32_32x32x16_bf16 v[64:79], v[136:139], v[128:131], v[64:79]
    v_mfma_f32_32x32x16_bf16 v[80:95], v[136:139], v[132:135], v[80:95]
    v_mfma_f32_32x32x16_bf16 v[96:111], v[140:143], v[128:131], v[96:111]
    v_mfma_f32_32x32x16_bf16 v[112:127], v[140:143], v[132:135], v[112:127]
    ds_read_b128 v[128:131], v23 offset:0
    ds_read_b128 v[132:135], v23 offset:4096
    ds_read_b64_tr_b16 v[136:137], v24 offset:24576
    ds_read_b64_tr_b16 v[138:139], v24 offset:26624
    ds_read_b64_tr_b16 v[140:141], v25 offset:24576
    ds_read_b64_tr_b16 v[142:143], v25 offset:26624
    s_waitcnt lgkmcnt(12)
    v_mfma_f32_32x32x16_bf16 v[64:79], v[152:155], v[144:147], v[64:79]
    v_mfma_f32_32x32x16_bf16 v[80:95], v[152:155], v[148:151], v[80:95]
    v_mfma_f32_32x32x16_bf16 v[96:111], v[156:159], v[144:147], v[96:111]
    v_mfma_f32_32x32x16_bf16 v[112:127], v[156:159], v[148:151], v[112:127]
    s_waitcnt lgkmcnt(6)
    v_mfma_f32_32x32x16_bf16 v[64:79], v[168:171], v[160:163], v[64:79]
    v_mfma_f32_32x32x16_bf16 v[80:95], v[168:171], v[164:167], v[80:95]
    v_mfma_f32_32x32x16_bf16 v[96:111], v[172:175], v[160:163], v[96:111]
    v_mfma_f32_32x32x16_bf16 v[112:127], v[172:175], v[164:167], v[112:127]
    s_waitcnt lgkmcnt(0)
    v_mfma_f32_32x32x16_bf16 v[64:79], v[136:139], v[128:131], v[64:79]
    v_mfma_f32_32x32x16_bf16 v[80:95], v[136:139], v[132:135], v[80:95]
    v_mfma_f32_32x32x16_bf16 v[96:111], v[140:143], v[128:131], v[96:111]
    v_mfma_f32_32x32x16_bf16 v[112:127], v[140:143], v[132:135], v[112:127]
    s_nop 7
    s_nop 7
    v_and_b32 v3, 31, v1
    v_and_b32 v4, 1, v2
    v_lshlrev_b32 v4, 6, v4
    v_add_u32 v4, v4, v3
    s_lshl_b32 s44, s40, 7
    v_add_u32 v4, s44, v4
    v_lshrrev_b32 v5, 5, v1
    v_lshlrev_b32 v5, 2, v5
    v_lshrrev_b32 v6, 1, v2
    s_add_u32 s24, s8, 34603008
    s_addc_u32 s25, s9, 0
    s_mov_b32 s26, 29360128
    s_mov_b32 s27, 0x00020000
    v_lshlrev_b32 v6, 6, v6
    v_add_u32 v5, v5, v6
    s_lshl_b32 s46, s42, 8
    v_add_u32 v5, s46, v5
    v_lshlrev_b32 v4, 9, v4
    v_add_u32 v4, v4, v5
    v_lshlrev_b32 v4, 2, v4
    s_mul_i32 s46, s43, 4194304
    v_add_u32 v4, s46, v4
    v_add_u32 v5, 65536, v4
    buffer_store_dwordx4 v[64:67], v4, s[24:27], 0 offen offset:0
    buffer_store_dwordx4 v[68:71], v4, s[24:27], 0 offen offset:32
    buffer_store_dwordx4 v[72:75], v4, s[24:27], 0 offen offset:64
    buffer_store_dwordx4 v[76:79], v4, s[24:27], 0 offen offset:96
    buffer_store_dwordx4 v[80:83], v5, s[24:27], 0 offen offset:0
    buffer_store_dwordx4 v[84:87], v5, s[24:27], 0 offen offset:32
    buffer_store_dwordx4 v[88:91], v5, s[24:27], 0 offen offset:64
    buffer_store_dwordx4 v[92:95], v5, s[24:27], 0 offen offset:96
    buffer_store_dwordx4 v[96:99], v4, s[24:27], 0 offen offset:128
    buffer_store_dwordx4 v[100:103], v4, s[24:27], 0 offen offset:160
    buffer_store_dwordx4 v[104:107], v4, s[24:27], 0 offen offset:192
    buffer_store_dwordx4 v[108:111], v4, s[24:27], 0 offen offset:224
    buffer_store_dwordx4 v[112:115], v5, s[24:27], 0 offen offset:128
    buffer_store_dwordx4 v[116:119], v5, s[24:27], 0 offen offset:160
    buffer_store_dwordx4 v[120:123], v5, s[24:27], 0 offen offset:192
    buffer_store_dwordx4 v[124:127], v5, s[24:27], 0 offen offset:224
down_kernel_done:
    s_endpgm
.globl final_kernel
.p2align 8
.type final_kernel,@function
final_kernel:
    s_cmp_ge_u32 s2, 512
    s_cbranch_scc1 final_kernel_done
    s_load_dwordx2 s[4:5], s[0:1], 88
    s_load_dwordx2 s[8:9], s[0:1], 104
    v_lshrrev_b32 v1, 6, v0
    v_and_b32 v2, 63, v0
    s_lshl_b32 s3, s2, 2
    v_add_u32 v1, s3, v1
    s_waitcnt lgkmcnt(0)
    s_mov_b32 s12, s4
    s_mov_b32 s13, s5
    s_mov_b32 s14, 2097152
    s_mov_b32 s15, 0x00020000
    s_mov_b32 s16, s8
    s_mov_b32 s17, s9
    s_mov_b32 s18, 12288
    s_mov_b32 s19, 0x00020000
    s_add_u32 s24, s8, 68157440
    s_addc_u32 s25, s9, 0
    s_mov_b32 s26, 2097152
    s_mov_b32 s27, 0x00020000
    s_add_u32 s28, s8, 34603008
    s_addc_u32 s29, s9, 0
    s_mov_b32 s30, 29360128
    s_mov_b32 s31, 0x00020000
    v_lshlrev_b32 v3, 10, v1
    v_lshlrev_b32 v4, 4, v2
    v_add_u32 v3, v3, v4
    v_lshlrev_b32 v5, 1, v3
    v_lshlrev_b32 v6, 5, v2
    buffer_load_dwordx4 v[16:19], v3, s[24:27], 0 offen
    s_mov_b32 s33, 10240
    buffer_load_dwordx4 v[48:51], v6, s[16:19], s33 offen
    buffer_load_dwordx4 v[52:55], v6, s[16:19], s33 offen offset:16
    s_mov_b32 s33, 0
    buffer_load_dwordx4 v[64:67], v5, s[28:31], s33 offen
    buffer_load_dwordx4 v[68:71], v5, s[28:31], s33 offen offset:16
    s_mov_b32 s33, 4194304
    buffer_load_dwordx4 v[72:75], v5, s[28:31], s33 offen
    buffer_load_dwordx4 v[76:79], v5, s[28:31], s33 offen offset:16
    s_mov_b32 s33, 8388608
    buffer_load_dwordx4 v[80:83], v5, s[28:31], s33 offen
    buffer_load_dwordx4 v[84:87], v5, s[28:31], s33 offen offset:16
    s_mov_b32 s33, 12582912
    buffer_load_dwordx4 v[88:91], v5, s[28:31], s33 offen
    buffer_load_dwordx4 v[92:95], v5, s[28:31], s33 offen offset:16
    s_mov_b32 s33, 16777216
    buffer_load_dwordx4 v[96:99], v5, s[28:31], s33 offen
    buffer_load_dwordx4 v[100:103], v5, s[28:31], s33 offen offset:16
    s_mov_b32 s33, 20971520
    buffer_load_dwordx4 v[104:107], v5, s[28:31], s33 offen
    buffer_load_dwordx4 v[108:111], v5, s[28:31], s33 offen offset:16
    s_mov_b32 s33, 25165824
    buffer_load_dwordx4 v[112:115], v5, s[28:31], s33 offen
    buffer_load_dwordx4 v[116:119], v5, s[28:31], s33 offen offset:16
    s_waitcnt vmcnt(12)
    v_mov_b32 v56, v64
    v_mov_b32 v57, v65
    v_mov_b32 v58, v66
    v_mov_b32 v59, v67
    v_mov_b32 v60, v68
    v_mov_b32 v61, v69
    v_mov_b32 v62, v70
    v_mov_b32 v63, v71
    s_waitcnt vmcnt(10)
    v_add_f32 v56, v56, v72
    v_add_f32 v57, v57, v73
    v_add_f32 v58, v58, v74
    v_add_f32 v59, v59, v75
    v_add_f32 v60, v60, v76
    v_add_f32 v61, v61, v77
    v_add_f32 v62, v62, v78
    v_add_f32 v63, v63, v79
    s_waitcnt vmcnt(8)
    v_add_f32 v56, v56, v80
    v_add_f32 v57, v57, v81
    v_add_f32 v58, v58, v82
    v_add_f32 v59, v59, v83
    v_add_f32 v60, v60, v84
    v_add_f32 v61, v61, v85
    v_add_f32 v62, v62, v86
    v_add_f32 v63, v63, v87
    s_waitcnt vmcnt(6)
    v_add_f32 v56, v56, v88
    v_add_f32 v57, v57, v89
    v_add_f32 v58, v58, v90
    v_add_f32 v59, v59, v91
    v_add_f32 v60, v60, v92
    v_add_f32 v61, v61, v93
    v_add_f32 v62, v62, v94
    v_add_f32 v63, v63, v95
    s_waitcnt vmcnt(4)
    v_add_f32 v56, v56, v96
    v_add_f32 v57, v57, v97
    v_add_f32 v58, v58, v98
    v_add_f32 v59, v59, v99
    v_add_f32 v60, v60, v100
    v_add_f32 v61, v61, v101
    v_add_f32 v62, v62, v102
    v_add_f32 v63, v63, v103
    s_waitcnt vmcnt(2)
    v_add_f32 v56, v56, v104
    v_add_f32 v57, v57, v105
    v_add_f32 v58, v58, v106
    v_add_f32 v59, v59, v107
    v_add_f32 v60, v60, v108
    v_add_f32 v61, v61, v109
    v_add_f32 v62, v62, v110
    v_add_f32 v63, v63, v111
    s_waitcnt vmcnt(0)
    v_add_f32 v56, v56, v112
    v_add_f32 v57, v57, v113
    v_add_f32 v58, v58, v114
    v_add_f32 v59, v59, v115
    v_add_f32 v60, v60, v116
    v_add_f32 v61, v61, v117
    v_add_f32 v62, v62, v118
    v_add_f32 v63, v63, v119
    v_lshlrev_b32 v20, 16, v16
    v_and_b32 v21, 0xffff0000, v16
    v_lshlrev_b32 v22, 16, v17
    v_and_b32 v23, 0xffff0000, v17
    v_lshlrev_b32 v24, 16, v18
    v_and_b32 v25, 0xffff0000, v18
    v_lshlrev_b32 v26, 16, v19
    v_and_b32 v27, 0xffff0000, v19
    v_cvt_pk_bf16_f32 v56, v56, v56
    v_lshlrev_b32 v56, 16, v56
    v_mul_f32 v56, v48, v56
    v_cvt_pk_bf16_f32 v56, v56, v56
    v_lshlrev_b32 v56, 16, v56
    v_add_f32 v20, v20, v56
    v_cvt_pk_bf16_f32 v57, v57, v57
    v_lshlrev_b32 v57, 16, v57
    v_mul_f32 v57, v49, v57
    v_cvt_pk_bf16_f32 v57, v57, v57
    v_lshlrev_b32 v57, 16, v57
    v_add_f32 v21, v21, v57
    v_cvt_pk_bf16_f32 v58, v58, v58
    v_lshlrev_b32 v58, 16, v58
    v_mul_f32 v58, v50, v58
    v_cvt_pk_bf16_f32 v58, v58, v58
    v_lshlrev_b32 v58, 16, v58
    v_add_f32 v22, v22, v58
    v_cvt_pk_bf16_f32 v59, v59, v59
    v_lshlrev_b32 v59, 16, v59
    v_mul_f32 v59, v51, v59
    v_cvt_pk_bf16_f32 v59, v59, v59
    v_lshlrev_b32 v59, 16, v59
    v_add_f32 v23, v23, v59
    v_cvt_pk_bf16_f32 v60, v60, v60
    v_lshlrev_b32 v60, 16, v60
    v_mul_f32 v60, v52, v60
    v_cvt_pk_bf16_f32 v60, v60, v60
    v_lshlrev_b32 v60, 16, v60
    v_add_f32 v24, v24, v60
    v_cvt_pk_bf16_f32 v61, v61, v61
    v_lshlrev_b32 v61, 16, v61
    v_mul_f32 v61, v53, v61
    v_cvt_pk_bf16_f32 v61, v61, v61
    v_lshlrev_b32 v61, 16, v61
    v_add_f32 v25, v25, v61
    v_cvt_pk_bf16_f32 v62, v62, v62
    v_lshlrev_b32 v62, 16, v62
    v_mul_f32 v62, v54, v62
    v_cvt_pk_bf16_f32 v62, v62, v62
    v_lshlrev_b32 v62, 16, v62
    v_add_f32 v26, v26, v62
    v_cvt_pk_bf16_f32 v63, v63, v63
    v_lshlrev_b32 v63, 16, v63
    v_mul_f32 v63, v55, v63
    v_cvt_pk_bf16_f32 v63, v63, v63
    v_lshlrev_b32 v63, 16, v63
    v_add_f32 v27, v27, v63
    v_cvt_pk_bf16_f32 v16, v20, v21
    v_cvt_pk_bf16_f32 v17, v22, v23
    v_cvt_pk_bf16_f32 v18, v24, v25
    v_cvt_pk_bf16_f32 v19, v26, v27
    buffer_store_dwordx4 v[16:19], v3, s[12:15], 0 offen
final_kernel_done:
    s_endpgm
.section .rodata,"a"
.p2align 6
.amdhsa_kernel mod_kernel
  .amdhsa_next_free_vgpr 72
  .amdhsa_next_free_sgpr 100
  .amdhsa_accum_offset 72
  .amdhsa_group_segment_fixed_size 0
  .amdhsa_kernarg_size 112
  .amdhsa_user_sgpr_count 2
  .amdhsa_user_sgpr_kernarg_segment_ptr 1
  .amdhsa_system_sgpr_workgroup_id_x 1
.end_amdhsa_kernel
.p2align 6
.amdhsa_kernel ln1_kernel
  .amdhsa_next_free_vgpr 128
  .amdhsa_next_free_sgpr 100
  .amdhsa_accum_offset 128
  .amdhsa_group_segment_fixed_size 0
  .amdhsa_kernarg_size 112
  .amdhsa_user_sgpr_count 2
  .amdhsa_user_sgpr_kernarg_segment_ptr 1
  .amdhsa_system_sgpr_workgroup_id_x 1
.end_amdhsa_kernel
.p2align 6
.amdhsa_kernel qproj_kernel
  .amdhsa_next_free_vgpr 192
  .amdhsa_next_free_sgpr 100
  .amdhsa_accum_offset 192
  .amdhsa_group_segment_fixed_size 0
  .amdhsa_kernarg_size 112
  .amdhsa_user_sgpr_count 2
  .amdhsa_user_sgpr_kernarg_segment_ptr 1
  .amdhsa_system_sgpr_workgroup_id_x 1
.end_amdhsa_kernel
.p2align 6
.amdhsa_kernel attn_kernel
  .amdhsa_next_free_vgpr 256
  .amdhsa_next_free_sgpr 100
  .amdhsa_accum_offset 256
  .amdhsa_group_segment_fixed_size 0
  .amdhsa_kernarg_size 112
  .amdhsa_user_sgpr_count 2
  .amdhsa_user_sgpr_kernarg_segment_ptr 1
  .amdhsa_system_sgpr_workgroup_id_x 1
.end_amdhsa_kernel
.p2align 6
.amdhsa_kernel wo_kernel
  .amdhsa_next_free_vgpr 192
  .amdhsa_next_free_sgpr 100
  .amdhsa_accum_offset 192
  .amdhsa_group_segment_fixed_size 0
  .amdhsa_kernarg_size 112
  .amdhsa_user_sgpr_count 2
  .amdhsa_user_sgpr_kernarg_segment_ptr 1
  .amdhsa_system_sgpr_workgroup_id_x 1
.end_amdhsa_kernel
.p2align 6
.amdhsa_kernel ln2_kernel
  .amdhsa_next_free_vgpr 128
  .amdhsa_next_free_sgpr 100
  .amdhsa_accum_offset 128
  .amdhsa_group_segment_fixed_size 0
  .amdhsa_kernarg_size 112
  .amdhsa_user_sgpr_count 2
  .amdhsa_user_sgpr_kernarg_segment_ptr 1
  .amdhsa_system_sgpr_workgroup_id_x 1
.end_amdhsa_kernel
.p2align 6
.amdhsa_kernel gateup_kernel
  .amdhsa_next_free_vgpr 192
  .amdhsa_next_free_sgpr 100
  .amdhsa_accum_offset 192
  .amdhsa_group_segment_fixed_size 0
  .amdhsa_kernarg_size 112
  .amdhsa_user_sgpr_count 2
  .amdhsa_user_sgpr_kernarg_segment_ptr 1
  .amdhsa_system_sgpr_workgroup_id_x 1
.end_amdhsa_kernel
.p2align 6
.amdhsa_kernel down_kernel
  .amdhsa_next_free_vgpr 192
  .amdhsa_next_free_sgpr 100
  .amdhsa_accum_offset 192
  .amdhsa_group_segment_fixed_size 0
  .amdhsa_kernarg_size 112
  .amdhsa_user_sgpr_count 2
  .amdhsa_user_sgpr_kernarg_segment_ptr 1
  .amdhsa_system_sgpr_workgroup_id_x 1
.end_amdhsa_kernel
.p2align 6
.amdhsa_kernel final_kernel
  .amdhsa_next_free_vgpr 128
  .amdhsa_next_free_sgpr 100
  .amdhsa_accum_offset 128
  .amdhsa_group_segment_fixed_size 0
  .amdhsa_kernarg_size 112
  .amdhsa_user_sgpr_count 2
  .amdhsa_user_sgpr_kernarg_segment_ptr 1
  .amdhsa_system_sgpr_workgroup_id_x 1
.end_amdhsa_kernel
```
